```python
import torch

def _softmax(x, axis=-1):
    return torch.softmax(x, dim=axis)
def _gelu(x):
    return torch.nn.functional.gelu(x, approximate="tanh")
def _silu(x):
    return torch.nn.functional.silu(x)
def _sigmoid(x):
    return torch.sigmoid(x)
def _layernorm(x, axis=-1, eps=1e-5):
    m = x.mean(dim=axis, keepdim=True)
    v = x.var(dim=axis, keepdim=True, unbiased=False)
    return (x - m) / torch.sqrt(v + eps)
def _scatter_add(tgt, idx, src, axis=0):
    return tgt.clone().index_add_(axis, idx, src)
def _segment_sum(src, seg, n):
    out = torch.zeros((n,) + src.shape[1:], dtype=src.dtype)
    return out.index_add_(0, seg, src)
def _pad(x, pw):
    flat = tuple(v for pair in reversed(pw) for v in pair)
    return torch.nn.functional.pad(x, flat)

kernel_name = 'sequential_preLN__compressed_kv_cla__mixer_token_mlp__prompt'

def setup_inputs():

    _w = (lambda a: (lambda t: t.to(torch.bfloat16) if t.is_floating_point() else t)(torch.as_tensor(a)))
    def _A_setup():
        B, H, Sq, Sk, D, M = 1, 32, 2048, 2048, 128, 576
        Dc = 4 * D
        return {
            "x": _w((lambda *s: torch.randn(*s, dtype=torch.bfloat16) * 0.05)(B, Sq, M)),
            "c_kv": _w((lambda *s: torch.randn(*s, dtype=torch.bfloat16) * 0.2)(B, Sk, Dc)),
            "w_q": _w((lambda *s: torch.randn(*s, dtype=torch.bfloat16) * 3.2)(M, H, D) * (M ** -0.5)),
            "w_uk": _w((lambda *s: torch.randn(*s, dtype=torch.bfloat16) * 6.4)(Dc, H, D) * (Dc ** -0.5)),
            "w_uv": _w((lambda *s: torch.randn(*s, dtype=torch.bfloat16) * 0.2)(Dc, H, D) * (Dc ** -0.5)),
            "w_o": _w((lambda *s: torch.randn(*s, dtype=torch.bfloat16) * 0.2)(H, D, M) * ((H * D) ** -0.5)),
        }
    _A_in = _A_setup()

    def _B_setup():
        B, S, D, F = 1, 2048, 576, 4608
        return {
            "x": _w((lambda *s: torch.randn(*s, dtype=torch.bfloat16) * 0.05)(B, S, D)),
            "w1": _w((lambda *s: torch.randn(*s, dtype=torch.bfloat16) * 0.4)(S, F) * (S ** -0.5)),
            "b1": _w((lambda *s: torch.randn(*s, dtype=torch.bfloat16) * 3.2)(F) * 0.02),
            "w2": _w((lambda *s: torch.randn(*s, dtype=torch.bfloat16) * 0.2)(F, S) * (F ** -0.5)),
            "b2": _w((lambda *s: torch.randn(*s, dtype=torch.bfloat16) * 0.8)(S) * 0.02),
        }
    _B_in = _B_setup()

    return {
        "A_x": _A_in["x"],
        "A_c_kv": _A_in["c_kv"],
        "A_w_q": _A_in["w_q"],
        "A_w_uk": _A_in["w_uk"],
        "A_w_uv": _A_in["w_uv"],
        "A_w_o": _A_in["w_o"],
        "B_x": _B_in["x"],
        "B_w1": _B_in["w1"],
        "B_b1": _B_in["b1"],
        "B_w2": _B_in["w2"],
        "B_b2": _B_in["b2"],
    }

def reference(A_x, A_c_kv, A_w_q, A_w_uk, A_w_uv, A_w_o, B_x, B_w1, B_b1, B_w2, B_b2):
    def _A_ref(x, c_kv, w_q, w_uk, w_uv, w_o):
        B, Sq, M = x.shape[0], x.shape[1], x.shape[2]
        Sk = c_kv.shape[1]
        H, D = w_q.shape[1], w_q.shape[2]
        q = torch.einsum("bqm,mhd->bhqd", x, w_q)
        k = torch.einsum("bkc,chd->bhkd", c_kv, w_uk)
        v = torch.einsum("bkc,chd->bhkd", c_kv, w_uv)
        scores = torch.einsum("bhqd,bhkd->bhqk", q, k) * (D ** -0.5)
        off = Sk - Sq
        qi = torch.arange(Sq)[:, None]
        kj = torch.arange(Sk)[None, :]
        cmask = kj <= (qi + off)
        scores = torch.where(cmask[None, None], scores, -1e9)
        p = _softmax(scores, axis=-1)
        ctx = torch.einsum("bhqk,bhkd->bhqd", p, v)
        return torch.einsum("bhqd,hdm->bqm", ctx, w_o)

    def _B_ref(x, w1, b1, w2, b2):
        B, S, D = x.shape
        h = _layernorm(x, axis=-1)
        u = torch.einsum("bsd,sf->bdf", h, w1) + b1
        u = _gelu(u)
        y = torch.einsum("bdf,fs->bds", u, w2) + b2
        return (lambda x, *d: x.permute(*d))(y, 0, 2, 1)

    x = A_x
    h = x + _A_ref(_layernorm(x, axis=-1), A_c_kv, A_w_q, A_w_uk, A_w_uv, A_w_o)
    h2 = h + _B_ref(_layernorm(h, axis=-1), B_w1, B_b1, B_w2, B_b2)
    return h2
```

```asm
; @launch kernel=kv_kernel grid=(256,1,1) block=(512,1,1) lds=131072
; @launch kernel=attn_kernel grid=(256,1,1) block=(512,1,1) lds=163840
; @launch kernel=oproj_kernel grid=(240,1,1) block=(512,1,1) lds=163840
; @launch kernel=ln2_kernel grid=(256,1,1) block=(576,1,1) lds=2048
; @launch kernel=mlp1_kernel grid=(256,1,1) block=(512,1,1) lds=143360
; @launch kernel=mlp2_kernel grid=(240,1,1) block=(512,1,1) lds=163840
; @launch kernel=fin_kernel grid=(256,1,1) block=(576,1,1) lds=2048
.amdgcn_target "amdgcn-amd-amdhsa--gfx950"
.text
.globl kv_kernel
.p2align 8
.type kv_kernel,@function
kv_kernel:
s_cmp_ge_u32 s2, 256
s_cbranch_scc1 .kv_end
v_readfirstlane_b32 s3, v0
v_and_b32 v0, 63, v0
s_lshr_b32 s3, s3, 6
s_load_dwordx2 s[8:9], s[0:1], 8
s_load_dwordx2 s[12:13], s[0:1], 24
s_load_dwordx2 s[16:17], s[0:1], 32
s_load_dwordx2 s[20:21], s[0:1], 104
s_load_dwordx2 s[24:25], s[0:1], 0
s_load_dwordx2 s[28:29], s[0:1], 104
s_load_dwordx2 s[32:33], s[0:1], 16
s_and_b32 s6, s2, 7
s_lshl_b32 s6, s6, 2
s_bfe_u32 s7, s2, 0x20003
s_add_u32 s6, s6, s7
s_lshr_b32 s7, s2, 5
s_lshl_b32 s50, s7, 18
s_lshl_b32 s51, s6, 8
s_mov_b32 s52, s51
s_mul_i32 s4, s3, 4
s_add_u32 s4, s4, 0
s_lshl_b32 s4, s4, 3
v_lshrrev_b32 v1, 3, v0
v_add_u32 v1, s4, v1
v_bfe_u32 v2, v1, 1, 3
v_and_b32 v3, 7, v0
v_xor_b32 v2, v2, v3
v_mul_u32_u24 v1, 1024, v1
v_lshl_add_u32 v8, v2, 4, v1
s_mul_i32 s4, s3, 4
s_add_u32 s4, s4, 1
s_lshl_b32 s4, s4, 3
v_lshrrev_b32 v1, 3, v0
v_add_u32 v1, s4, v1
v_bfe_u32 v2, v1, 1, 3
v_and_b32 v3, 7, v0
v_xor_b32 v2, v2, v3
v_mul_u32_u24 v1, 1024, v1
v_lshl_add_u32 v9, v2, 4, v1
s_mul_i32 s4, s3, 4
s_add_u32 s4, s4, 2
s_lshl_b32 s4, s4, 3
v_lshrrev_b32 v1, 3, v0
v_add_u32 v1, s4, v1
v_bfe_u32 v2, v1, 1, 3
v_and_b32 v3, 7, v0
v_xor_b32 v2, v2, v3
v_mul_u32_u24 v1, 1024, v1
v_lshl_add_u32 v10, v2, 4, v1
s_mul_i32 s4, s3, 4
s_add_u32 s4, s4, 3
s_lshl_b32 s4, s4, 3
v_lshrrev_b32 v1, 3, v0
v_add_u32 v1, s4, v1
v_bfe_u32 v2, v1, 1, 3
v_and_b32 v3, 7, v0
v_xor_b32 v2, v2, v3
v_mul_u32_u24 v1, 1024, v1
v_lshl_add_u32 v11, v2, 4, v1
s_mul_i32 s53, s3, 4096
s_add_u32 s53, s53, 0
s_mul_i32 s4, s3, 2
s_add_u32 s4, s4, 0
s_lshl_b32 s4, s4, 6
v_add_u32 v1, s4, v0
v_mul_u32_u24 v2, 4096, v1
v_lshrrev_b32 v2, 16, v2
v_mul_u32_u24 v3, 16, v2
v_sub_u32 v3, v1, v3
v_and_b32 v4, 3, v2
v_lshlrev_b32 v4, 2, v4
v_xor_b32 v3, v3, v4
v_mul_u32_u24 v2, 8192, v2
v_lshl_add_u32 v12, v3, 4, v2
s_mul_i32 s4, s3, 2
s_add_u32 s4, s4, 1
s_lshl_b32 s4, s4, 6
v_add_u32 v1, s4, v0
v_mul_u32_u24 v2, 4096, v1
v_lshrrev_b32 v2, 16, v2
v_mul_u32_u24 v3, 16, v2
v_sub_u32 v3, v1, v3
v_and_b32 v4, 3, v2
v_lshlrev_b32 v4, 2, v4
v_xor_b32 v3, v3, v4
v_mul_u32_u24 v2, 8192, v2
v_lshl_add_u32 v13, v3, 4, v2
s_mul_i32 s54, s3, 2048
s_add_u32 s54, s54, 32768
s_mul_i32 s4, s3, 2
s_add_u32 s4, s4, 0
s_lshl_b32 s4, s4, 6
v_add_u32 v1, s4, v0
v_mul_u32_u24 v2, 4096, v1
v_lshrrev_b32 v2, 16, v2
v_mul_u32_u24 v3, 16, v2
v_sub_u32 v3, v1, v3
v_and_b32 v4, 3, v2
v_lshlrev_b32 v4, 2, v4
v_xor_b32 v3, v3, v4
v_mul_u32_u24 v2, 8192, v2
v_lshl_add_u32 v14, v3, 4, v2
s_mul_i32 s4, s3, 2
s_add_u32 s4, s4, 1
s_lshl_b32 s4, s4, 6
v_add_u32 v1, s4, v0
v_mul_u32_u24 v2, 4096, v1
v_lshrrev_b32 v2, 16, v2
v_mul_u32_u24 v3, 16, v2
v_sub_u32 v3, v1, v3
v_and_b32 v4, 3, v2
v_lshlrev_b32 v4, 2, v4
v_xor_b32 v3, v3, v4
v_mul_u32_u24 v2, 8192, v2
v_lshl_add_u32 v15, v3, 4, v2
s_mul_i32 s55, s3, 2048
s_add_u32 s55, s55, 49152
s_and_b32 s56, s3, 3
s_lshl_b32 s56, s56, 1
s_mov_b32 s57, 0
v_and_b32 v1, 31, v0
v_bfe_u32 v2, v0, 1, 3
v_lshrrev_b32 v3, 5, v0
v_lshlrev_b32 v1, 7, v1
s_lshl_b32 s4, s56, 12
s_add_u32 s4, s4, 0
v_add_u32 v1, s4, v1
v_bfe_u32 v2, v0, 1, 4
v_and_b32 v2, 7, v2
v_or_b32 v4, 0, v3
v_xor_b32 v4, v4, v2
v_lshl_add_u32 v16, v4, 4, v1
v_or_b32 v4, 2, v3
v_xor_b32 v4, v4, v2
v_lshl_add_u32 v17, v4, 4, v1
v_or_b32 v4, 4, v3
v_xor_b32 v4, v4, v2
v_lshl_add_u32 v18, v4, 4, v1
v_or_b32 v4, 6, v3
v_xor_b32 v4, v4, v2
v_lshl_add_u32 v19, v4, 4, v1
s_lshl_b32 s58, s6, 6
s_lshl_b32 s4, s7, 3
s_add_u32 s58, s58, s4
s_add_u32 s58, s58, s56
s_lshl_b32 s58, s58, 13
s_cmp_ge_u32 s3, 4
s_cbranch_scc1 .kv_L1
v_bfe_u32 v1, v0, 2, 2
v_lshrrev_b32 v2, 5, v0
v_lshl_add_u32 v2, v2, 3, v1
v_mul_u32_u24 v2, 256, v2
v_bfe_u32 v3, v0, 4, 1
v_lshl_add_u32 v2, v3, 5, v2
v_and_b32 v3, 3, v0
v_lshl_add_u32 v2, v3, 3, v2
v_add_u32 v2, 32768, v2
s_add_u32 s4, s57, 0
v_xor_b32 v3, s4, v1
v_lshl_add_u32 v20, v3, 6, v2
s_add_u32 s4, s57, 1
v_xor_b32 v3, s4, v1
v_lshl_add_u32 v21, v3, 6, v2
s_add_u32 s4, s57, 2
v_xor_b32 v3, s4, v1
v_lshl_add_u32 v22, v3, 6, v2
s_add_u32 s4, s57, 3
v_xor_b32 v3, s4, v1
v_lshl_add_u32 v23, v3, 6, v2
s_mov_b32 s40, 8
s_mov_b32 s44, 8
s_mov_b32 s41, 0
s_mov_b32 s43, 0
s_mov_b32 s45, 65536
s_waitcnt lgkmcnt(0)
s_mov_b32 s10, 2097152
s_mov_b32 s11, 0x20000
s_mov_b32 s14, 4194304
s_mov_b32 s15, 0x20000
s_mov_b32 s18, 4194304
s_mov_b32 s19, 0x20000
s_add_u32 s20, s20, 4194304
s_addc_u32 s21, s21, 0
s_mov_b32 s22, 33554432
s_mov_b32 s23, 0x20000
s_mov_b32 s26, 2359296
s_mov_b32 s27, 0x20000
s_mov_b32 s30, 2359296
s_mov_b32 s31, 0x20000
s_mov_b32 s34, 4718592
s_mov_b32 s35, 0x20000
s_lshl_b32 s4, s2, 3
s_add_u32 s4, s4, s3
s_mul_i32 s4, s4, 1152
v_lshlrev_b32 v1, 2, v0
v_add_u32 v2, 1024, v1
v_cmp_gt_u32 vcc, 32, v0
v_mov_b32 v3, 0x7fff0000
v_cndmask_b32 v2, v3, v2, vcc
buffer_load_dword v216, v1, s[24:27], s4 offen offset:0
buffer_load_dword v217, v1, s[24:27], s4 offen offset:256
buffer_load_dword v218, v1, s[24:27], s4 offen offset:512
buffer_load_dword v219, v1, s[24:27], s4 offen offset:768
buffer_load_dword v220, v2, s[24:27], s4 offen
s_mov_b32 s59, s4
v_mov_b32 v221, v2
s_lshl_b32 s4, s2, 3
s_add_u32 s4, s4, s3
s_mul_i32 s4, s4, 2304
v_mul_u32_u24 v4, 36, v0
v_add_u32 v222, s4, v4
s_cmp_gt_i32 s44, 0
s_cselect_b32 s10, s10, 0
s_cselect_b32 s14, s14, 0
s_cselect_b32 s18, s18, 0
s_sub_u32 s44, s44, 1
s_add_u32 m0, s41, s53
s_nop 0
buffer_load_dwordx4 v8, s[8:11], s50 offen lds
s_add_u32 m0, m0, 1024
s_nop 0
buffer_load_dwordx4 v9, s[8:11], s50 offen lds
s_add_u32 m0, m0, 1024
s_nop 0
buffer_load_dwordx4 v10, s[8:11], s50 offen lds
s_add_u32 m0, m0, 1024
s_nop 0
buffer_load_dwordx4 v11, s[8:11], s50 offen lds
s_add_u32 s50, s50, 128
s_add_u32 m0, s41, s54
s_nop 0
buffer_load_dwordx4 v12, s[12:15], s51 offen lds
s_add_u32 m0, m0, 1024
s_nop 0
buffer_load_dwordx4 v13, s[12:15], s51 offen lds
s_add_u32 s51, s51, 524288
s_add_u32 m0, s41, s55
s_nop 0
buffer_load_dwordx4 v14, s[16:19], s52 offen lds
s_add_u32 m0, m0, 1024
s_nop 0
buffer_load_dwordx4 v15, s[16:19], s52 offen lds
s_add_u32 s52, s52, 524288
s_add_u32 s41, s41, 65536
s_cmp_eq_u32 s41, 131072
s_cselect_b32 s41, 0, s41
s_cmp_gt_i32 s44, 0
s_cselect_b32 s10, s10, 0
s_cselect_b32 s14, s14, 0
s_cselect_b32 s18, s18, 0
s_sub_u32 s44, s44, 1
s_add_u32 m0, s41, s53
s_nop 0
buffer_load_dwordx4 v8, s[8:11], s50 offen lds
s_add_u32 m0, m0, 1024
s_nop 0
buffer_load_dwordx4 v9, s[8:11], s50 offen lds
s_add_u32 m0, m0, 1024
s_nop 0
buffer_load_dwordx4 v10, s[8:11], s50 offen lds
s_add_u32 m0, m0, 1024
s_nop 0
buffer_load_dwordx4 v11, s[8:11], s50 offen lds
s_add_u32 s50, s50, 128
buffer_load_dword v223, v222, s[32:35], 0 offen
v_mov_b32 v88, 0
v_mov_b32 v89, 0
v_mov_b32 v90, 0
v_mov_b32 v91, 0
v_mov_b32 v92, 0
v_mov_b32 v93, 0
v_mov_b32 v94, 0
v_mov_b32 v95, 0
v_mov_b32 v96, 0
v_mov_b32 v97, 0
v_mov_b32 v98, 0
v_mov_b32 v99, 0
v_mov_b32 v100, 0
v_mov_b32 v101, 0
v_mov_b32 v102, 0
v_mov_b32 v103, 0
v_mov_b32 v104, 0
v_mov_b32 v105, 0
v_mov_b32 v106, 0
v_mov_b32 v107, 0
v_mov_b32 v108, 0
v_mov_b32 v109, 0
v_mov_b32 v110, 0
v_mov_b32 v111, 0
v_mov_b32 v112, 0
v_mov_b32 v113, 0
v_mov_b32 v114, 0
v_mov_b32 v115, 0
v_mov_b32 v116, 0
v_mov_b32 v117, 0
v_mov_b32 v118, 0
v_mov_b32 v119, 0
v_mov_b32 v120, 0
v_mov_b32 v121, 0
v_mov_b32 v122, 0
v_mov_b32 v123, 0
v_mov_b32 v124, 0
v_mov_b32 v125, 0
v_mov_b32 v126, 0
v_mov_b32 v127, 0
v_mov_b32 v128, 0
v_mov_b32 v129, 0
v_mov_b32 v130, 0
v_mov_b32 v131, 0
v_mov_b32 v132, 0
v_mov_b32 v133, 0
v_mov_b32 v134, 0
v_mov_b32 v135, 0
v_mov_b32 v136, 0
v_mov_b32 v137, 0
v_mov_b32 v138, 0
v_mov_b32 v139, 0
v_mov_b32 v140, 0
v_mov_b32 v141, 0
v_mov_b32 v142, 0
v_mov_b32 v143, 0
v_mov_b32 v144, 0
v_mov_b32 v145, 0
v_mov_b32 v146, 0
v_mov_b32 v147, 0
v_mov_b32 v148, 0
v_mov_b32 v149, 0
v_mov_b32 v150, 0
v_mov_b32 v151, 0
v_mov_b32 v152, 0
v_mov_b32 v153, 0
v_mov_b32 v154, 0
v_mov_b32 v155, 0
v_mov_b32 v156, 0
v_mov_b32 v157, 0
v_mov_b32 v158, 0
v_mov_b32 v159, 0
v_mov_b32 v160, 0
v_mov_b32 v161, 0
v_mov_b32 v162, 0
v_mov_b32 v163, 0
v_mov_b32 v164, 0
v_mov_b32 v165, 0
v_mov_b32 v166, 0
v_mov_b32 v167, 0
v_mov_b32 v168, 0
v_mov_b32 v169, 0
v_mov_b32 v170, 0
v_mov_b32 v171, 0
v_mov_b32 v172, 0
v_mov_b32 v173, 0
v_mov_b32 v174, 0
v_mov_b32 v175, 0
v_mov_b32 v176, 0
v_mov_b32 v177, 0
v_mov_b32 v178, 0
v_mov_b32 v179, 0
v_mov_b32 v180, 0
v_mov_b32 v181, 0
v_mov_b32 v182, 0
v_mov_b32 v183, 0
v_mov_b32 v184, 0
v_mov_b32 v185, 0
v_mov_b32 v186, 0
v_mov_b32 v187, 0
v_mov_b32 v188, 0
v_mov_b32 v189, 0
v_mov_b32 v190, 0
v_mov_b32 v191, 0
v_mov_b32 v192, 0
v_mov_b32 v193, 0
v_mov_b32 v194, 0
v_mov_b32 v195, 0
v_mov_b32 v196, 0
v_mov_b32 v197, 0
v_mov_b32 v198, 0
v_mov_b32 v199, 0
v_mov_b32 v200, 0
v_mov_b32 v201, 0
v_mov_b32 v202, 0
v_mov_b32 v203, 0
v_mov_b32 v204, 0
v_mov_b32 v205, 0
v_mov_b32 v206, 0
v_mov_b32 v207, 0
v_mov_b32 v208, 0
v_mov_b32 v209, 0
v_mov_b32 v210, 0
v_mov_b32 v211, 0
v_mov_b32 v212, 0
v_mov_b32 v213, 0
v_mov_b32 v214, 0
v_mov_b32 v215, 0
s_waitcnt vmcnt(4)
s_barrier
ds_read_b64_tr_b16 v[40:41], v20 offset:0
ds_read_b64_tr_b16 v[42:43], v20 offset:1024
ds_read_b64_tr_b16 v[44:45], v21 offset:0
ds_read_b64_tr_b16 v[46:47], v21 offset:1024
ds_read_b64_tr_b16 v[48:49], v22 offset:0
ds_read_b64_tr_b16 v[50:51], v22 offset:1024
ds_read_b64_tr_b16 v[52:53], v23 offset:0
ds_read_b64_tr_b16 v[54:55], v23 offset:1024
ds_read_b128 v[56:59], v16 offset:0
ds_read_b128 v[60:63], v16 offset:4096
.kv_L3:
ds_read_b64_tr_b16 v[64:65], v20 offset:4096
ds_read_b64_tr_b16 v[66:67], v20 offset:5120
ds_read_b64_tr_b16 v[68:69], v21 offset:4096
s_waitcnt lgkmcnt(3)
v_mfma_f32_32x32x16_bf16 v[88:103], v[40:43], v[56:59], v[88:103]
ds_read_b64_tr_b16 v[70:71], v21 offset:5120
v_mfma_f32_32x32x16_bf16 v[104:119], v[40:43], v[60:63], v[104:119]
s_add_u32 m0, s41, s54
s_nop 0
buffer_load_dwordx4 v12, s[12:15], s51 offen lds
v_mfma_f32_32x32x16_bf16 v[120:135], v[44:47], v[56:59], v[120:135]
ds_read_b64_tr_b16 v[72:73], v22 offset:4096
ds_read_b64_tr_b16 v[74:75], v22 offset:5120
v_mfma_f32_32x32x16_bf16 v[136:151], v[44:47], v[60:63], v[136:151]
s_add_u32 m0, m0, 1024
s_nop 0
buffer_load_dwordx4 v13, s[12:15], s51 offen lds
s_add_u32 s51, s51, 524288
v_mfma_f32_32x32x16_bf16 v[152:167], v[48:51], v[56:59], v[152:167]
ds_read_b64_tr_b16 v[76:77], v23 offset:4096
v_mfma_f32_32x32x16_bf16 v[168:183], v[48:51], v[60:63], v[168:183]
ds_read_b64_tr_b16 v[78:79], v23 offset:5120
s_add_u32 m0, s41, s55
s_nop 0
buffer_load_dwordx4 v14, s[16:19], s52 offen lds
v_mfma_f32_32x32x16_bf16 v[184:199], v[52:55], v[56:59], v[184:199]
ds_read_b128 v[80:83], v17 offset:0
v_mfma_f32_32x32x16_bf16 v[200:215], v[52:55], v[60:63], v[200:215]
ds_read_b128 v[84:87], v17 offset:4096
s_add_u32 m0, m0, 1024
s_nop 0
buffer_load_dwordx4 v15, s[16:19], s52 offen lds
s_add_u32 s52, s52, 524288
s_add_u32 s41, s41, 65536
s_cmp_eq_u32 s41, 131072
s_cselect_b32 s41, 0, s41
ds_read_b64_tr_b16 v[40:41], v20 offset:8192
ds_read_b64_tr_b16 v[42:43], v20 offset:9216
ds_read_b64_tr_b16 v[44:45], v21 offset:8192
s_waitcnt lgkmcnt(3)
v_mfma_f32_32x32x16_bf16 v[88:103], v[64:67], v[80:83], v[88:103]
v_mfma_f32_32x32x16_bf16 v[104:119], v[64:67], v[84:87], v[104:119]
ds_read_b64_tr_b16 v[46:47], v21 offset:9216
v_mfma_f32_32x32x16_bf16 v[120:135], v[68:71], v[80:83], v[120:135]
ds_read_b64_tr_b16 v[48:49], v22 offset:8192
v_mfma_f32_32x32x16_bf16 v[136:151], v[68:71], v[84:87], v[136:151]
ds_read_b64_tr_b16 v[50:51], v22 offset:9216
v_mfma_f32_32x32x16_bf16 v[152:167], v[72:75], v[80:83], v[152:167]
ds_read_b64_tr_b16 v[52:53], v23 offset:8192
v_mfma_f32_32x32x16_bf16 v[168:183], v[72:75], v[84:87], v[168:183]
ds_read_b64_tr_b16 v[54:55], v23 offset:9216
v_mfma_f32_32x32x16_bf16 v[184:199], v[76:79], v[80:83], v[184:199]
ds_read_b128 v[56:59], v18 offset:0
v_mfma_f32_32x32x16_bf16 v[200:215], v[76:79], v[84:87], v[200:215]
ds_read_b128 v[60:63], v18 offset:4096
ds_read_b64_tr_b16 v[64:65], v20 offset:12288
ds_read_b64_tr_b16 v[66:67], v20 offset:13312
ds_read_b64_tr_b16 v[68:69], v21 offset:12288
s_waitcnt lgkmcnt(3)
v_mfma_f32_32x32x16_bf16 v[88:103], v[40:43], v[56:59], v[88:103]
v_mfma_f32_32x32x16_bf16 v[104:119], v[40:43], v[60:63], v[104:119]
ds_read_b64_tr_b16 v[70:71], v21 offset:13312
v_mfma_f32_32x32x16_bf16 v[120:135], v[44:47], v[56:59], v[120:135]
ds_read_b64_tr_b16 v[72:73], v22 offset:12288
v_mfma_f32_32x32x16_bf16 v[136:151], v[44:47], v[60:63], v[136:151]
ds_read_b64_tr_b16 v[74:75], v22 offset:13312
v_mfma_f32_32x32x16_bf16 v[152:167], v[48:51], v[56:59], v[152:167]
ds_read_b64_tr_b16 v[76:77], v23 offset:12288
v_mfma_f32_32x32x16_bf16 v[168:183], v[48:51], v[60:63], v[168:183]
ds_read_b64_tr_b16 v[78:79], v23 offset:13312
v_mfma_f32_32x32x16_bf16 v[184:199], v[52:55], v[56:59], v[184:199]
ds_read_b128 v[80:83], v19 offset:0
v_mfma_f32_32x32x16_bf16 v[200:215], v[52:55], v[60:63], v[200:215]
ds_read_b128 v[84:87], v19 offset:4096
s_add_u32 s43, s43, 65536
s_cmp_eq_u32 s43, 131072
s_cselect_b32 s42, -65536, s45
s_cselect_b32 s43, 0, s43
s_waitcnt lgkmcnt(0)
v_add_u32 v20, s42, v20
v_add_u32 v21, s42, v21
v_add_u32 v22, s42, v22
v_add_u32 v23, s42, v23
v_add_u32 v16, s42, v16
v_add_u32 v17, s42, v17
v_add_u32 v18, s42, v18
v_add_u32 v19, s42, v19
s_waitcnt vmcnt(0)
s_barrier
v_mfma_f32_32x32x16_bf16 v[88:103], v[64:67], v[80:83], v[88:103]
ds_read_b64_tr_b16 v[40:41], v20 offset:0
ds_read_b64_tr_b16 v[42:43], v20 offset:1024
ds_read_b64_tr_b16 v[44:45], v21 offset:0
v_mfma_f32_32x32x16_bf16 v[104:119], v[64:67], v[84:87], v[104:119]
ds_read_b64_tr_b16 v[46:47], v21 offset:1024
s_cmp_gt_i32 s44, 0
s_cselect_b32 s10, s10, 0
s_cselect_b32 s14, s14, 0
s_cselect_b32 s18, s18, 0
s_sub_u32 s44, s44, 1
s_add_u32 m0, s41, s53
s_nop 0
buffer_load_dwordx4 v8, s[8:11], s50 offen lds
v_mfma_f32_32x32x16_bf16 v[120:135], v[68:71], v[80:83], v[120:135]
ds_read_b64_tr_b16 v[48:49], v22 offset:0
v_mfma_f32_32x32x16_bf16 v[136:151], v[68:71], v[84:87], v[136:151]
ds_read_b64_tr_b16 v[50:51], v22 offset:1024
s_add_u32 m0, m0, 1024
s_nop 0
buffer_load_dwordx4 v9, s[8:11], s50 offen lds
v_mfma_f32_32x32x16_bf16 v[152:167], v[72:75], v[80:83], v[152:167]
ds_read_b64_tr_b16 v[52:53], v23 offset:0
v_mfma_f32_32x32x16_bf16 v[168:183], v[72:75], v[84:87], v[168:183]
ds_read_b64_tr_b16 v[54:55], v23 offset:1024
s_add_u32 m0, m0, 1024
s_nop 0
buffer_load_dwordx4 v10, s[8:11], s50 offen lds
v_mfma_f32_32x32x16_bf16 v[184:199], v[76:79], v[80:83], v[184:199]
ds_read_b128 v[56:59], v16 offset:0
v_mfma_f32_32x32x16_bf16 v[200:215], v[76:79], v[84:87], v[200:215]
ds_read_b128 v[60:63], v16 offset:4096
s_add_u32 m0, m0, 1024
s_nop 0
buffer_load_dwordx4 v11, s[8:11], s50 offen lds
s_add_u32 s50, s50, 128
s_sub_u32 s40, s40, 1
s_cmp_lg_u32 s40, 0
s_cbranch_scc1 .kv_L3
s_waitcnt vmcnt(0) lgkmcnt(0)
s_nop 7
s_nop 7
v_lshlrev_b32 v1, 4, v0
v_cvt_pk_bf16_f32 v40, v88, v89
v_cvt_pk_bf16_f32 v41, v90, v91
v_cvt_pk_bf16_f32 v42, v92, v93
v_cvt_pk_bf16_f32 v43, v94, v95
buffer_store_dwordx4 v[40:43], v1, s[20:23], s58 offen offset:0 sc1
v_cvt_pk_bf16_f32 v44, v96, v97
v_cvt_pk_bf16_f32 v45, v98, v99
v_cvt_pk_bf16_f32 v46, v100, v101
v_cvt_pk_bf16_f32 v47, v102, v103
buffer_store_dwordx4 v[44:47], v1, s[20:23], s58 offen offset:1024 sc1
v_cvt_pk_bf16_f32 v48, v120, v121
v_cvt_pk_bf16_f32 v49, v122, v123
v_cvt_pk_bf16_f32 v50, v124, v125
v_cvt_pk_bf16_f32 v51, v126, v127
buffer_store_dwordx4 v[48:51], v1, s[20:23], s58 offen offset:2048 sc1
v_cvt_pk_bf16_f32 v52, v128, v129
v_cvt_pk_bf16_f32 v53, v130, v131
v_cvt_pk_bf16_f32 v54, v132, v133
v_cvt_pk_bf16_f32 v55, v134, v135
buffer_store_dwordx4 v[52:55], v1, s[20:23], s58 offen offset:3072 sc1
s_add_u32 s58, s58, 4096
v_cvt_pk_bf16_f32 v56, v152, v153
v_cvt_pk_bf16_f32 v57, v154, v155
v_cvt_pk_bf16_f32 v58, v156, v157
v_cvt_pk_bf16_f32 v59, v158, v159
buffer_store_dwordx4 v[56:59], v1, s[20:23], s58 offen offset:0 sc1
v_cvt_pk_bf16_f32 v60, v160, v161
v_cvt_pk_bf16_f32 v61, v162, v163
v_cvt_pk_bf16_f32 v62, v164, v165
v_cvt_pk_bf16_f32 v63, v166, v167
buffer_store_dwordx4 v[60:63], v1, s[20:23], s58 offen offset:1024 sc1
v_cvt_pk_bf16_f32 v64, v184, v185
v_cvt_pk_bf16_f32 v65, v186, v187
v_cvt_pk_bf16_f32 v66, v188, v189
v_cvt_pk_bf16_f32 v67, v190, v191
buffer_store_dwordx4 v[64:67], v1, s[20:23], s58 offen offset:2048 sc1
v_cvt_pk_bf16_f32 v68, v192, v193
v_cvt_pk_bf16_f32 v69, v194, v195
v_cvt_pk_bf16_f32 v70, v196, v197
v_cvt_pk_bf16_f32 v71, v198, v199
buffer_store_dwordx4 v[68:71], v1, s[20:23], s58 offen offset:3072 sc1
s_add_u32 s58, s58, 4096
v_cvt_pk_bf16_f32 v40, v104, v105
v_cvt_pk_bf16_f32 v41, v106, v107
v_cvt_pk_bf16_f32 v42, v108, v109
v_cvt_pk_bf16_f32 v43, v110, v111
buffer_store_dwordx4 v[40:43], v1, s[20:23], s58 offen offset:0 sc1
v_cvt_pk_bf16_f32 v44, v112, v113
v_cvt_pk_bf16_f32 v45, v114, v115
v_cvt_pk_bf16_f32 v46, v116, v117
v_cvt_pk_bf16_f32 v47, v118, v119
buffer_store_dwordx4 v[44:47], v1, s[20:23], s58 offen offset:1024 sc1
v_cvt_pk_bf16_f32 v48, v136, v137
v_cvt_pk_bf16_f32 v49, v138, v139
v_cvt_pk_bf16_f32 v50, v140, v141
v_cvt_pk_bf16_f32 v51, v142, v143
buffer_store_dwordx4 v[48:51], v1, s[20:23], s58 offen offset:2048 sc1
v_cvt_pk_bf16_f32 v52, v144, v145
v_cvt_pk_bf16_f32 v53, v146, v147
v_cvt_pk_bf16_f32 v54, v148, v149
v_cvt_pk_bf16_f32 v55, v150, v151
buffer_store_dwordx4 v[52:55], v1, s[20:23], s58 offen offset:3072 sc1
s_add_u32 s58, s58, 4096
v_cvt_pk_bf16_f32 v56, v168, v169
v_cvt_pk_bf16_f32 v57, v170, v171
v_cvt_pk_bf16_f32 v58, v172, v173
v_cvt_pk_bf16_f32 v59, v174, v175
buffer_store_dwordx4 v[56:59], v1, s[20:23], s58 offen offset:0 sc1
v_cvt_pk_bf16_f32 v60, v176, v177
v_cvt_pk_bf16_f32 v61, v178, v179
v_cvt_pk_bf16_f32 v62, v180, v181
v_cvt_pk_bf16_f32 v63, v182, v183
buffer_store_dwordx4 v[60:63], v1, s[20:23], s58 offen offset:1024 sc1
v_cvt_pk_bf16_f32 v64, v200, v201
v_cvt_pk_bf16_f32 v65, v202, v203
v_cvt_pk_bf16_f32 v66, v204, v205
v_cvt_pk_bf16_f32 v67, v206, v207
buffer_store_dwordx4 v[64:67], v1, s[20:23], s58 offen offset:2048 sc1
v_cvt_pk_bf16_f32 v68, v208, v209
v_cvt_pk_bf16_f32 v69, v210, v211
v_cvt_pk_bf16_f32 v70, v212, v213
v_cvt_pk_bf16_f32 v71, v214, v215
buffer_store_dwordx4 v[68:71], v1, s[20:23], s58 offen offset:3072 sc1
s_add_u32 s58, s58, 4096
s_branch .kv_L2
.kv_L1:
s_add_u32 s58, s58, 16777216
v_bfe_u32 v1, v0, 2, 2
v_lshrrev_b32 v2, 5, v0
v_lshl_add_u32 v2, v2, 3, v1
v_mul_u32_u24 v2, 256, v2
v_bfe_u32 v3, v0, 4, 1
v_lshl_add_u32 v2, v3, 5, v2
v_and_b32 v3, 3, v0
v_lshl_add_u32 v2, v3, 3, v2
v_add_u32 v2, 49152, v2
s_add_u32 s4, s57, 0
v_xor_b32 v3, s4, v1
v_lshl_add_u32 v20, v3, 6, v2
s_add_u32 s4, s57, 1
v_xor_b32 v3, s4, v1
v_lshl_add_u32 v21, v3, 6, v2
s_add_u32 s4, s57, 2
v_xor_b32 v3, s4, v1
v_lshl_add_u32 v22, v3, 6, v2
s_add_u32 s4, s57, 3
v_xor_b32 v3, s4, v1
v_lshl_add_u32 v23, v3, 6, v2
s_mov_b32 s40, 8
s_mov_b32 s44, 8
s_mov_b32 s41, 0
s_mov_b32 s43, 0
s_mov_b32 s45, 65536
s_waitcnt lgkmcnt(0)
s_mov_b32 s10, 2097152
s_mov_b32 s11, 0x20000
s_mov_b32 s14, 4194304
s_mov_b32 s15, 0x20000
s_mov_b32 s18, 4194304
s_mov_b32 s19, 0x20000
s_add_u32 s20, s20, 4194304
s_addc_u32 s21, s21, 0
s_mov_b32 s22, 33554432
s_mov_b32 s23, 0x20000
s_mov_b32 s26, 2359296
s_mov_b32 s27, 0x20000
s_mov_b32 s30, 2359296
s_mov_b32 s31, 0x20000
s_mov_b32 s34, 4718592
s_mov_b32 s35, 0x20000
s_lshl_b32 s4, s2, 3
s_add_u32 s4, s4, s3
s_mul_i32 s4, s4, 1152
v_lshlrev_b32 v1, 2, v0
v_add_u32 v2, 1024, v1
v_cmp_gt_u32 vcc, 32, v0
v_mov_b32 v3, 0x7fff0000
v_cndmask_b32 v2, v3, v2, vcc
buffer_load_dword v216, v1, s[24:27], s4 offen offset:0
buffer_load_dword v217, v1, s[24:27], s4 offen offset:256
buffer_load_dword v218, v1, s[24:27], s4 offen offset:512
buffer_load_dword v219, v1, s[24:27], s4 offen offset:768
buffer_load_dword v220, v2, s[24:27], s4 offen
s_mov_b32 s59, s4
v_mov_b32 v221, v2
s_lshl_b32 s4, s2, 3
s_add_u32 s4, s4, s3
s_mul_i32 s4, s4, 2304
v_mul_u32_u24 v4, 36, v0
v_add_u32 v222, s4, v4
s_cmp_gt_i32 s44, 0
s_cselect_b32 s10, s10, 0
s_cselect_b32 s14, s14, 0
s_cselect_b32 s18, s18, 0
s_sub_u32 s44, s44, 1
s_add_u32 m0, s41, s53
s_nop 0
buffer_load_dwordx4 v8, s[8:11], s50 offen lds
s_add_u32 m0, m0, 1024
s_nop 0
buffer_load_dwordx4 v9, s[8:11], s50 offen lds
s_add_u32 m0, m0, 1024
s_nop 0
buffer_load_dwordx4 v10, s[8:11], s50 offen lds
s_add_u32 m0, m0, 1024
s_nop 0
buffer_load_dwordx4 v11, s[8:11], s50 offen lds
s_add_u32 s50, s50, 128
s_add_u32 m0, s41, s54
s_nop 0
buffer_load_dwordx4 v12, s[12:15], s51 offen lds
s_add_u32 m0, m0, 1024
s_nop 0
buffer_load_dwordx4 v13, s[12:15], s51 offen lds
s_add_u32 s51, s51, 524288
s_add_u32 m0, s41, s55
s_nop 0
buffer_load_dwordx4 v14, s[16:19], s52 offen lds
s_add_u32 m0, m0, 1024
s_nop 0
buffer_load_dwordx4 v15, s[16:19], s52 offen lds
s_add_u32 s52, s52, 524288
s_add_u32 s41, s41, 65536
s_cmp_eq_u32 s41, 131072
s_cselect_b32 s41, 0, s41
s_cmp_gt_i32 s44, 0
s_cselect_b32 s10, s10, 0
s_cselect_b32 s14, s14, 0
s_cselect_b32 s18, s18, 0
s_sub_u32 s44, s44, 1
s_add_u32 m0, s41, s53
s_nop 0
buffer_load_dwordx4 v8, s[8:11], s50 offen lds
s_add_u32 m0, m0, 1024
s_nop 0
buffer_load_dwordx4 v9, s[8:11], s50 offen lds
s_add_u32 m0, m0, 1024
s_nop 0
buffer_load_dwordx4 v10, s[8:11], s50 offen lds
s_add_u32 m0, m0, 1024
s_nop 0
buffer_load_dwordx4 v11, s[8:11], s50 offen lds
s_add_u32 s50, s50, 128
buffer_load_dword v223, v222, s[32:35], 0 offen
v_mov_b32 v88, 0
v_mov_b32 v89, 0
v_mov_b32 v90, 0
v_mov_b32 v91, 0
v_mov_b32 v92, 0
v_mov_b32 v93, 0
v_mov_b32 v94, 0
v_mov_b32 v95, 0
v_mov_b32 v96, 0
v_mov_b32 v97, 0
v_mov_b32 v98, 0
v_mov_b32 v99, 0
v_mov_b32 v100, 0
v_mov_b32 v101, 0
v_mov_b32 v102, 0
v_mov_b32 v103, 0
v_mov_b32 v104, 0
v_mov_b32 v105, 0
v_mov_b32 v106, 0
v_mov_b32 v107, 0
v_mov_b32 v108, 0
v_mov_b32 v109, 0
v_mov_b32 v110, 0
v_mov_b32 v111, 0
v_mov_b32 v112, 0
v_mov_b32 v113, 0
v_mov_b32 v114, 0
v_mov_b32 v115, 0
v_mov_b32 v116, 0
v_mov_b32 v117, 0
v_mov_b32 v118, 0
v_mov_b32 v119, 0
v_mov_b32 v120, 0
v_mov_b32 v121, 0
v_mov_b32 v122, 0
v_mov_b32 v123, 0
v_mov_b32 v124, 0
v_mov_b32 v125, 0
v_mov_b32 v126, 0
v_mov_b32 v127, 0
v_mov_b32 v128, 0
v_mov_b32 v129, 0
v_mov_b32 v130, 0
v_mov_b32 v131, 0
v_mov_b32 v132, 0
v_mov_b32 v133, 0
v_mov_b32 v134, 0
v_mov_b32 v135, 0
v_mov_b32 v136, 0
v_mov_b32 v137, 0
v_mov_b32 v138, 0
v_mov_b32 v139, 0
v_mov_b32 v140, 0
v_mov_b32 v141, 0
v_mov_b32 v142, 0
v_mov_b32 v143, 0
v_mov_b32 v144, 0
v_mov_b32 v145, 0
v_mov_b32 v146, 0
v_mov_b32 v147, 0
v_mov_b32 v148, 0
v_mov_b32 v149, 0
v_mov_b32 v150, 0
v_mov_b32 v151, 0
v_mov_b32 v152, 0
v_mov_b32 v153, 0
v_mov_b32 v154, 0
v_mov_b32 v155, 0
v_mov_b32 v156, 0
v_mov_b32 v157, 0
v_mov_b32 v158, 0
v_mov_b32 v159, 0
v_mov_b32 v160, 0
v_mov_b32 v161, 0
v_mov_b32 v162, 0
v_mov_b32 v163, 0
v_mov_b32 v164, 0
v_mov_b32 v165, 0
v_mov_b32 v166, 0
v_mov_b32 v167, 0
v_mov_b32 v168, 0
v_mov_b32 v169, 0
v_mov_b32 v170, 0
v_mov_b32 v171, 0
v_mov_b32 v172, 0
v_mov_b32 v173, 0
v_mov_b32 v174, 0
v_mov_b32 v175, 0
v_mov_b32 v176, 0
v_mov_b32 v177, 0
v_mov_b32 v178, 0
v_mov_b32 v179, 0
v_mov_b32 v180, 0
v_mov_b32 v181, 0
v_mov_b32 v182, 0
v_mov_b32 v183, 0
v_mov_b32 v184, 0
v_mov_b32 v185, 0
v_mov_b32 v186, 0
v_mov_b32 v187, 0
v_mov_b32 v188, 0
v_mov_b32 v189, 0
v_mov_b32 v190, 0
v_mov_b32 v191, 0
v_mov_b32 v192, 0
v_mov_b32 v193, 0
v_mov_b32 v194, 0
v_mov_b32 v195, 0
v_mov_b32 v196, 0
v_mov_b32 v197, 0
v_mov_b32 v198, 0
v_mov_b32 v199, 0
v_mov_b32 v200, 0
v_mov_b32 v201, 0
v_mov_b32 v202, 0
v_mov_b32 v203, 0
v_mov_b32 v204, 0
v_mov_b32 v205, 0
v_mov_b32 v206, 0
v_mov_b32 v207, 0
v_mov_b32 v208, 0
v_mov_b32 v209, 0
v_mov_b32 v210, 0
v_mov_b32 v211, 0
v_mov_b32 v212, 0
v_mov_b32 v213, 0
v_mov_b32 v214, 0
v_mov_b32 v215, 0
s_waitcnt vmcnt(4)
s_barrier
ds_read_b128 v[40:43], v16 offset:0
ds_read_b128 v[44:47], v16 offset:4096
ds_read_b64_tr_b16 v[48:49], v20 offset:0
ds_read_b64_tr_b16 v[50:51], v20 offset:1024
ds_read_b64_tr_b16 v[52:53], v21 offset:0
ds_read_b64_tr_b16 v[54:55], v21 offset:1024
ds_read_b64_tr_b16 v[56:57], v22 offset:0
ds_read_b64_tr_b16 v[58:59], v22 offset:1024
ds_read_b64_tr_b16 v[60:61], v23 offset:0
ds_read_b64_tr_b16 v[62:63], v23 offset:1024
.kv_L4:
ds_read_b128 v[64:67], v17 offset:0
ds_read_b128 v[68:71], v17 offset:4096
ds_read_b64_tr_b16 v[72:73], v20 offset:4096
s_waitcnt lgkmcnt(3)
v_mfma_f32_32x32x16_bf16 v[88:103], v[40:43], v[48:51], v[88:103]
ds_read_b64_tr_b16 v[74:75], v20 offset:5120
v_mfma_f32_32x32x16_bf16 v[104:119], v[40:43], v[52:55], v[104:119]
s_add_u32 m0, s41, s54
s_nop 0
buffer_load_dwordx4 v12, s[12:15], s51 offen lds
v_mfma_f32_32x32x16_bf16 v[120:135], v[40:43], v[56:59], v[120:135]
ds_read_b64_tr_b16 v[76:77], v21 offset:4096
ds_read_b64_tr_b16 v[78:79], v21 offset:5120
v_mfma_f32_32x32x16_bf16 v[136:151], v[40:43], v[60:63], v[136:151]
s_add_u32 m0, m0, 1024
s_nop 0
buffer_load_dwordx4 v13, s[12:15], s51 offen lds
s_add_u32 s51, s51, 524288
v_mfma_f32_32x32x16_bf16 v[152:167], v[44:47], v[48:51], v[152:167]
ds_read_b64_tr_b16 v[80:81], v22 offset:4096
v_mfma_f32_32x32x16_bf16 v[168:183], v[44:47], v[52:55], v[168:183]
ds_read_b64_tr_b16 v[82:83], v22 offset:5120
s_add_u32 m0, s41, s55
s_nop 0
buffer_load_dwordx4 v14, s[16:19], s52 offen lds
v_mfma_f32_32x32x16_bf16 v[184:199], v[44:47], v[56:59], v[184:199]
ds_read_b64_tr_b16 v[84:85], v23 offset:4096
v_mfma_f32_32x32x16_bf16 v[200:215], v[44:47], v[60:63], v[200:215]
ds_read_b64_tr_b16 v[86:87], v23 offset:5120
s_add_u32 m0, m0, 1024
s_nop 0
buffer_load_dwordx4 v15, s[16:19], s52 offen lds
s_add_u32 s52, s52, 524288
s_add_u32 s41, s41, 65536
s_cmp_eq_u32 s41, 131072
s_cselect_b32 s41, 0, s41
ds_read_b128 v[40:43], v18 offset:0
ds_read_b128 v[44:47], v18 offset:4096
ds_read_b64_tr_b16 v[48:49], v20 offset:8192
s_waitcnt lgkmcnt(3)
v_mfma_f32_32x32x16_bf16 v[88:103], v[64:67], v[72:75], v[88:103]
v_mfma_f32_32x32x16_bf16 v[104:119], v[64:67], v[76:79], v[104:119]
ds_read_b64_tr_b16 v[50:51], v20 offset:9216
v_mfma_f32_32x32x16_bf16 v[120:135], v[64:67], v[80:83], v[120:135]
ds_read_b64_tr_b16 v[52:53], v21 offset:8192
v_mfma_f32_32x32x16_bf16 v[136:151], v[64:67], v[84:87], v[136:151]
ds_read_b64_tr_b16 v[54:55], v21 offset:9216
v_mfma_f32_32x32x16_bf16 v[152:167], v[68:71], v[72:75], v[152:167]
ds_read_b64_tr_b16 v[56:57], v22 offset:8192
v_mfma_f32_32x32x16_bf16 v[168:183], v[68:71], v[76:79], v[168:183]
ds_read_b64_tr_b16 v[58:59], v22 offset:9216
v_mfma_f32_32x32x16_bf16 v[184:199], v[68:71], v[80:83], v[184:199]
ds_read_b64_tr_b16 v[60:61], v23 offset:8192
v_mfma_f32_32x32x16_bf16 v[200:215], v[68:71], v[84:87], v[200:215]
ds_read_b64_tr_b16 v[62:63], v23 offset:9216
ds_read_b128 v[64:67], v19 offset:0
ds_read_b128 v[68:71], v19 offset:4096
ds_read_b64_tr_b16 v[72:73], v20 offset:12288
s_waitcnt lgkmcnt(3)
v_mfma_f32_32x32x16_bf16 v[88:103], v[40:43], v[48:51], v[88:103]
v_mfma_f32_32x32x16_bf16 v[104:119], v[40:43], v[52:55], v[104:119]
ds_read_b64_tr_b16 v[74:75], v20 offset:13312
v_mfma_f32_32x32x16_bf16 v[120:135], v[40:43], v[56:59], v[120:135]
ds_read_b64_tr_b16 v[76:77], v21 offset:12288
v_mfma_f32_32x32x16_bf16 v[136:151], v[40:43], v[60:63], v[136:151]
ds_read_b64_tr_b16 v[78:79], v21 offset:13312
v_mfma_f32_32x32x16_bf16 v[152:167], v[44:47], v[48:51], v[152:167]
ds_read_b64_tr_b16 v[80:81], v22 offset:12288
v_mfma_f32_32x32x16_bf16 v[168:183], v[44:47], v[52:55], v[168:183]
ds_read_b64_tr_b16 v[82:83], v22 offset:13312
v_mfma_f32_32x32x16_bf16 v[184:199], v[44:47], v[56:59], v[184:199]
ds_read_b64_tr_b16 v[84:85], v23 offset:12288
v_mfma_f32_32x32x16_bf16 v[200:215], v[44:47], v[60:63], v[200:215]
ds_read_b64_tr_b16 v[86:87], v23 offset:13312
s_add_u32 s43, s43, 65536
s_cmp_eq_u32 s43, 131072
s_cselect_b32 s42, -65536, s45
s_cselect_b32 s43, 0, s43
s_waitcnt lgkmcnt(0)
v_add_u32 v16, s42, v16
v_add_u32 v17, s42, v17
v_add_u32 v18, s42, v18
v_add_u32 v19, s42, v19
v_add_u32 v20, s42, v20
v_add_u32 v21, s42, v21
v_add_u32 v22, s42, v22
v_add_u32 v23, s42, v23
s_waitcnt vmcnt(0)
s_barrier
v_mfma_f32_32x32x16_bf16 v[88:103], v[64:67], v[72:75], v[88:103]
ds_read_b128 v[40:43], v16 offset:0
ds_read_b128 v[44:47], v16 offset:4096
ds_read_b64_tr_b16 v[48:49], v20 offset:0
v_mfma_f32_32x32x16_bf16 v[104:119], v[64:67], v[76:79], v[104:119]
ds_read_b64_tr_b16 v[50:51], v20 offset:1024
s_cmp_gt_i32 s44, 0
s_cselect_b32 s10, s10, 0
s_cselect_b32 s14, s14, 0
s_cselect_b32 s18, s18, 0
s_sub_u32 s44, s44, 1
s_add_u32 m0, s41, s53
s_nop 0
buffer_load_dwordx4 v8, s[8:11], s50 offen lds
v_mfma_f32_32x32x16_bf16 v[120:135], v[64:67], v[80:83], v[120:135]
ds_read_b64_tr_b16 v[52:53], v21 offset:0
v_mfma_f32_32x32x16_bf16 v[136:151], v[64:67], v[84:87], v[136:151]
ds_read_b64_tr_b16 v[54:55], v21 offset:1024
s_add_u32 m0, m0, 1024
s_nop 0
buffer_load_dwordx4 v9, s[8:11], s50 offen lds
v_mfma_f32_32x32x16_bf16 v[152:167], v[68:71], v[72:75], v[152:167]
ds_read_b64_tr_b16 v[56:57], v22 offset:0
v_mfma_f32_32x32x16_bf16 v[168:183], v[68:71], v[76:79], v[168:183]
ds_read_b64_tr_b16 v[58:59], v22 offset:1024
s_add_u32 m0, m0, 1024
s_nop 0
buffer_load_dwordx4 v10, s[8:11], s50 offen lds
v_mfma_f32_32x32x16_bf16 v[184:199], v[68:71], v[80:83], v[184:199]
ds_read_b64_tr_b16 v[60:61], v23 offset:0
v_mfma_f32_32x32x16_bf16 v[200:215], v[68:71], v[84:87], v[200:215]
ds_read_b64_tr_b16 v[62:63], v23 offset:1024
s_add_u32 m0, m0, 1024
s_nop 0
buffer_load_dwordx4 v11, s[8:11], s50 offen lds
s_add_u32 s50, s50, 128
s_sub_u32 s40, s40, 1
s_cmp_lg_u32 s40, 0
s_cbranch_scc1 .kv_L4
s_waitcnt vmcnt(0) lgkmcnt(0)
s_nop 7
s_nop 7
v_lshlrev_b32 v1, 4, v0
v_cvt_pk_bf16_f32 v40, v88, v89
v_cvt_pk_bf16_f32 v41, v90, v91
v_cvt_pk_bf16_f32 v42, v92, v93
v_cvt_pk_bf16_f32 v43, v94, v95
buffer_store_dwordx4 v[40:43], v1, s[20:23], s58 offen offset:0 sc1
v_cvt_pk_bf16_f32 v44, v96, v97
v_cvt_pk_bf16_f32 v45, v98, v99
v_cvt_pk_bf16_f32 v46, v100, v101
v_cvt_pk_bf16_f32 v47, v102, v103
buffer_store_dwordx4 v[44:47], v1, s[20:23], s58 offen offset:1024 sc1
v_cvt_pk_bf16_f32 v48, v104, v105
v_cvt_pk_bf16_f32 v49, v106, v107
v_cvt_pk_bf16_f32 v50, v108, v109
v_cvt_pk_bf16_f32 v51, v110, v111
buffer_store_dwordx4 v[48:51], v1, s[20:23], s58 offen offset:2048 sc1
v_cvt_pk_bf16_f32 v52, v112, v113
v_cvt_pk_bf16_f32 v53, v114, v115
v_cvt_pk_bf16_f32 v54, v116, v117
v_cvt_pk_bf16_f32 v55, v118, v119
buffer_store_dwordx4 v[52:55], v1, s[20:23], s58 offen offset:3072 sc1
s_add_u32 s58, s58, 4096
v_cvt_pk_bf16_f32 v56, v120, v121
v_cvt_pk_bf16_f32 v57, v122, v123
v_cvt_pk_bf16_f32 v58, v124, v125
v_cvt_pk_bf16_f32 v59, v126, v127
buffer_store_dwordx4 v[56:59], v1, s[20:23], s58 offen offset:0 sc1
v_cvt_pk_bf16_f32 v60, v128, v129
v_cvt_pk_bf16_f32 v61, v130, v131
v_cvt_pk_bf16_f32 v62, v132, v133
v_cvt_pk_bf16_f32 v63, v134, v135
buffer_store_dwordx4 v[60:63], v1, s[20:23], s58 offen offset:1024 sc1
v_cvt_pk_bf16_f32 v64, v136, v137
v_cvt_pk_bf16_f32 v65, v138, v139
v_cvt_pk_bf16_f32 v66, v140, v141
v_cvt_pk_bf16_f32 v67, v142, v143
buffer_store_dwordx4 v[64:67], v1, s[20:23], s58 offen offset:2048 sc1
v_cvt_pk_bf16_f32 v68, v144, v145
v_cvt_pk_bf16_f32 v69, v146, v147
v_cvt_pk_bf16_f32 v70, v148, v149
v_cvt_pk_bf16_f32 v71, v150, v151
buffer_store_dwordx4 v[68:71], v1, s[20:23], s58 offen offset:3072 sc1
s_add_u32 s58, s58, 4096
v_cvt_pk_bf16_f32 v40, v152, v153
v_cvt_pk_bf16_f32 v41, v154, v155
v_cvt_pk_bf16_f32 v42, v156, v157
v_cvt_pk_bf16_f32 v43, v158, v159
buffer_store_dwordx4 v[40:43], v1, s[20:23], s58 offen offset:0 sc1
v_cvt_pk_bf16_f32 v44, v160, v161
v_cvt_pk_bf16_f32 v45, v162, v163
v_cvt_pk_bf16_f32 v46, v164, v165
v_cvt_pk_bf16_f32 v47, v166, v167
buffer_store_dwordx4 v[44:47], v1, s[20:23], s58 offen offset:1024 sc1
v_cvt_pk_bf16_f32 v48, v168, v169
v_cvt_pk_bf16_f32 v49, v170, v171
v_cvt_pk_bf16_f32 v50, v172, v173
v_cvt_pk_bf16_f32 v51, v174, v175
buffer_store_dwordx4 v[48:51], v1, s[20:23], s58 offen offset:2048 sc1
v_cvt_pk_bf16_f32 v52, v176, v177
v_cvt_pk_bf16_f32 v53, v178, v179
v_cvt_pk_bf16_f32 v54, v180, v181
v_cvt_pk_bf16_f32 v55, v182, v183
buffer_store_dwordx4 v[52:55], v1, s[20:23], s58 offen offset:3072 sc1
s_add_u32 s58, s58, 4096
v_cvt_pk_bf16_f32 v56, v184, v185
v_cvt_pk_bf16_f32 v57, v186, v187
v_cvt_pk_bf16_f32 v58, v188, v189
v_cvt_pk_bf16_f32 v59, v190, v191
buffer_store_dwordx4 v[56:59], v1, s[20:23], s58 offen offset:0 sc1
v_cvt_pk_bf16_f32 v60, v192, v193
v_cvt_pk_bf16_f32 v61, v194, v195
v_cvt_pk_bf16_f32 v62, v196, v197
v_cvt_pk_bf16_f32 v63, v198, v199
buffer_store_dwordx4 v[60:63], v1, s[20:23], s58 offen offset:1024 sc1
v_cvt_pk_bf16_f32 v64, v200, v201
v_cvt_pk_bf16_f32 v65, v202, v203
v_cvt_pk_bf16_f32 v66, v204, v205
v_cvt_pk_bf16_f32 v67, v206, v207
buffer_store_dwordx4 v[64:67], v1, s[20:23], s58 offen offset:2048 sc1
v_cvt_pk_bf16_f32 v68, v208, v209
v_cvt_pk_bf16_f32 v69, v210, v211
v_cvt_pk_bf16_f32 v70, v212, v213
v_cvt_pk_bf16_f32 v71, v214, v215
buffer_store_dwordx4 v[68:71], v1, s[20:23], s58 offen offset:3072 sc1
s_add_u32 s58, s58, 4096
.kv_L2:
v_lshlrev_b32 v1, 2, v0
v_mov_b32 v2, v221
v_cmp_gt_u32 vcc, 32, v0
v_lshlrev_b32 v110, 16, v216
v_and_b32 v111, 0xffff0000, v216
v_lshlrev_b32 v112, 16, v217
v_and_b32 v113, 0xffff0000, v217
v_lshlrev_b32 v114, 16, v218
v_and_b32 v115, 0xffff0000, v218
v_lshlrev_b32 v116, 16, v219
v_and_b32 v117, 0xffff0000, v219
v_lshlrev_b32 v118, 16, v220
v_and_b32 v119, 0xffff0000, v220
v_add_f32 v4, v110, v111
v_add_f32 v4, v4, v112
v_add_f32 v4, v4, v113
v_add_f32 v4, v4, v114
v_add_f32 v4, v4, v115
v_add_f32 v4, v4, v116
v_add_f32 v4, v4, v117
v_add_f32 v4, v4, v118
v_add_f32 v4, v4, v119
s_nop 1
v_add_f32_dpp v4, v4, v4 row_ror:8 row_mask:0xf bank_mask:0xf
s_nop 1
v_add_f32_dpp v4, v4, v4 row_ror:4 row_mask:0xf bank_mask:0xf
s_nop 1
v_add_f32_dpp v4, v4, v4 row_ror:2 row_mask:0xf bank_mask:0xf
s_nop 1
v_add_f32_dpp v4, v4, v4 row_ror:1 row_mask:0xf bank_mask:0xf
v_mov_b32 v5, v4
s_nop 1
v_permlane16_swap_b32 v5, v4
s_nop 1
v_add_f32 v4, v4, v5
v_mov_b32 v5, v4
s_nop 1
v_permlane32_swap_b32 v5, v4
s_nop 1
v_add_f32 v4, v4, v5
v_mul_f32 v4, 0x3ae38e39, v4
v_sub_f32 v110, v110, v4
v_sub_f32 v111, v111, v4
v_sub_f32 v112, v112, v4
v_sub_f32 v113, v113, v4
v_sub_f32 v114, v114, v4
v_sub_f32 v115, v115, v4
v_sub_f32 v116, v116, v4
v_sub_f32 v117, v117, v4
v_sub_f32 v118, v118, v4
v_sub_f32 v119, v119, v4
v_cndmask_b32 v118, 0, v118, vcc
v_cndmask_b32 v119, 0, v119, vcc
v_mul_f32 v4, v110, v110
v_fmac_f32 v4, v111, v111
v_fmac_f32 v4, v112, v112
v_fmac_f32 v4, v113, v113
v_fmac_f32 v4, v114, v114
v_fmac_f32 v4, v115, v115
v_fmac_f32 v4, v116, v116
v_fmac_f32 v4, v117, v117
v_fmac_f32 v4, v118, v118
v_fmac_f32 v4, v119, v119
s_nop 1
v_add_f32_dpp v4, v4, v4 row_ror:8 row_mask:0xf bank_mask:0xf
s_nop 1
v_add_f32_dpp v4, v4, v4 row_ror:4 row_mask:0xf bank_mask:0xf
s_nop 1
v_add_f32_dpp v4, v4, v4 row_ror:2 row_mask:0xf bank_mask:0xf
s_nop 1
v_add_f32_dpp v4, v4, v4 row_ror:1 row_mask:0xf bank_mask:0xf
v_mov_b32 v5, v4
s_nop 1
v_permlane16_swap_b32 v5, v4
s_nop 1
v_add_f32 v4, v4, v5
v_mov_b32 v5, v4
s_nop 1
v_permlane32_swap_b32 v5, v4
s_nop 1
v_add_f32 v4, v4, v5
v_mov_b32 v5, 0x3727c5ac
v_fmac_f32 v5, 0x3ae38e39, v4
v_rsq_f32 v4, v5
s_nop 0
v_mul_f32 v5, v5, v4
v_mul_f32 v5, v5, v4
v_fma_f32 v5, v5, -0.5, 1.0
v_add_f32 v5, 0.5, v5
v_mul_f32 v4, v4, v5
v_mul_f32 v110, v4, v110
v_mul_f32 v111, v4, v111
v_mul_f32 v112, v4, v112
v_mul_f32 v113, v4, v113
v_mul_f32 v114, v4, v114
v_mul_f32 v115, v4, v115
v_mul_f32 v116, v4, v116
v_mul_f32 v117, v4, v117
v_mul_f32 v118, v4, v118
v_mul_f32 v119, v4, v119
v_cvt_pk_bf16_f32 v100, v110, v111
v_cvt_pk_bf16_f32 v101, v112, v113
v_cvt_pk_bf16_f32 v102, v114, v115
v_cvt_pk_bf16_f32 v103, v116, v117
v_cvt_pk_bf16_f32 v104, v118, v119
buffer_store_dword v100, v1, s[28:31], s59 offen offset:0 sc1
buffer_store_dword v101, v1, s[28:31], s59 offen offset:256 sc1
buffer_store_dword v102, v1, s[28:31], s59 offen offset:512 sc1
buffer_store_dword v103, v1, s[28:31], s59 offen offset:768 sc1
buffer_store_dword v104, v2, s[28:31], s59 offen sc1
.kv_end:
s_endpgm
.globl attn_kernel
.p2align 8
.type attn_kernel,@function
attn_kernel:
s_cmp_ge_u32 s2, 256
s_cbranch_scc1 .attn_end
v_readfirstlane_b32 s3, v0
v_and_b32 v0, 63, v0
s_lshr_b32 s3, s3, 6
s_load_dwordx2 s[8:9], s[0:1], 104
s_load_dwordx2 s[12:13], s[0:1], 16
s_load_dwordx2 s[16:17], s[0:1], 104
s_load_dwordx2 s[20:21], s[0:1], 104
s_load_dwordx2 s[24:25], s[0:1], 104
s_load_dwordx2 s[28:29], s[0:1], 40
s_load_dwordx2 s[32:33], s[0:1], 56
s_and_b32 s6, s2, 7
s_lshl_b32 s6, s6, 2
s_bfe_u32 s7, s2, 0x20003
s_add_u32 s6, s6, s7
s_lshr_b32 s7, s2, 5
s_cmp_lt_u32 s3, 4
s_cbranch_scc1 .attn_np
s_setprio 1
.attn_np:
s_lshr_b32 s60, s3, 2
s_and_b32 s61, s3, 3
s_sub_u32 s62, 15, s7
s_mov_b32 s50, 0
s_lshl_b32 s51, s6, 8
s_mul_i32 s4, s3, 4
s_add_u32 s4, s4, 0
s_lshl_b32 s4, s4, 3
v_lshrrev_b32 v1, 3, v0
v_add_u32 v1, s4, v1
v_bfe_u32 v2, v1, 1, 3
v_and_b32 v3, 7, v0
v_xor_b32 v2, v2, v3
v_mul_u32_u24 v1, 1152, v1
v_lshl_add_u32 v16, v2, 4, v1
s_mul_i32 s4, s3, 4
s_add_u32 s4, s4, 1
s_lshl_b32 s4, s4, 3
v_lshrrev_b32 v1, 3, v0
v_add_u32 v1, s4, v1
v_bfe_u32 v2, v1, 1, 3
v_and_b32 v3, 7, v0
v_xor_b32 v2, v2, v3
v_mul_u32_u24 v1, 1152, v1
v_lshl_add_u32 v17, v2, 4, v1
s_mul_i32 s4, s3, 4
s_add_u32 s4, s4, 2
s_lshl_b32 s4, s4, 3
v_lshrrev_b32 v1, 3, v0
v_add_u32 v1, s4, v1
v_bfe_u32 v2, v1, 1, 3
v_and_b32 v3, 7, v0
v_xor_b32 v2, v2, v3
v_mul_u32_u24 v1, 1152, v1
v_lshl_add_u32 v18, v2, 4, v1
s_mul_i32 s4, s3, 4
s_add_u32 s4, s4, 3
s_lshl_b32 s4, s4, 3
v_lshrrev_b32 v1, 3, v0
v_add_u32 v1, s4, v1
v_bfe_u32 v2, v1, 1, 3
v_and_b32 v3, 7, v0
v_xor_b32 v2, v2, v3
v_mul_u32_u24 v1, 1152, v1
v_lshl_add_u32 v19, v2, 4, v1
s_mul_i32 s53, s3, 4096
s_add_u32 s53, s53, 0
s_mul_i32 s4, s3, 2
s_add_u32 s4, s4, 0
s_lshl_b32 s4, s4, 6
v_add_u32 v1, s4, v0
v_mul_u32_u24 v2, 4096, v1
v_lshrrev_b32 v2, 16, v2
v_mul_u32_u24 v3, 16, v2
v_sub_u32 v3, v1, v3
v_and_b32 v4, 3, v2
v_lshlrev_b32 v4, 2, v4
v_xor_b32 v3, v3, v4
v_mul_u32_u24 v2, 8192, v2
v_lshl_add_u32 v20, v3, 4, v2
s_mul_i32 s4, s3, 2
s_add_u32 s4, s4, 1
s_lshl_b32 s4, s4, 6
v_add_u32 v1, s4, v0
v_mul_u32_u24 v2, 4096, v1
v_lshrrev_b32 v2, 16, v2
v_mul_u32_u24 v3, 16, v2
v_sub_u32 v3, v1, v3
v_and_b32 v4, 3, v2
v_lshlrev_b32 v4, 2, v4
v_xor_b32 v3, v3, v4
v_mul_u32_u24 v2, 8192, v2
v_lshl_add_u32 v21, v3, 4, v2
s_mul_i32 s54, s3, 2048
s_add_u32 s54, s54, 32768
s_cmp_eq_u32 s60, 0
s_cselect_b32 s4, s62, s7
s_sub_u32 s4, s4, s60
s_mul_i32 s4, s4, 147456
v_add_u32 v16, s4, v16
v_add_u32 v17, s4, v17
v_add_u32 v18, s4, v18
v_add_u32 v19, s4, v19
s_and_b32 s56, s3, 6
s_and_b32 s57, s3, 1
s_lshl_b32 s57, s57, 1
v_and_b32 v1, 31, v0
v_bfe_u32 v2, v0, 1, 3
v_lshrrev_b32 v3, 5, v0
v_lshlrev_b32 v1, 7, v1
s_lshl_b32 s4, s56, 12
s_add_u32 s4, s4, 0
v_add_u32 v1, s4, v1
v_bfe_u32 v2, v0, 1, 4
v_and_b32 v2, 7, v2
v_or_b32 v4, 0, v3
v_xor_b32 v4, v4, v2
v_lshl_add_u32 v22, v4, 4, v1
v_or_b32 v4, 2, v3
v_xor_b32 v4, v4, v2
v_lshl_add_u32 v23, v4, 4, v1
v_or_b32 v4, 4, v3
v_xor_b32 v4, v4, v2
v_lshl_add_u32 v24, v4, 4, v1
v_or_b32 v4, 6, v3
v_xor_b32 v4, v4, v2
v_lshl_add_u32 v25, v4, 4, v1
v_bfe_u32 v1, v0, 2, 2
v_lshrrev_b32 v2, 5, v0
v_lshl_add_u32 v2, v2, 3, v1
v_mul_u32_u24 v2, 256, v2
v_bfe_u32 v3, v0, 4, 1
v_lshl_add_u32 v2, v3, 5, v2
v_and_b32 v3, 3, v0
v_lshl_add_u32 v2, v3, 3, v2
v_add_u32 v2, 32768, v2
s_add_u32 s4, s57, 0
v_xor_b32 v3, s4, v1
v_lshl_add_u32 v26, v3, 6, v2
s_add_u32 s4, s57, 1
v_xor_b32 v3, s4, v1
v_lshl_add_u32 v27, v3, 6, v2
s_lshl_b32 s4, s60, 14
v_lshl_add_u32 v8, v0, 4, s4
v_add_u32 v9, 0x10000, v8
s_lshl_b32 s63, s3, 12
v_lshl_add_u32 v10, v0, 4, s63
s_lshl_b32 s64, s6, 19
s_add_u32 s65, s63, 0x10000
s_waitcnt lgkmcnt(0)
s_mov_b32 s10, 2359296
s_mov_b32 s11, 0x20000
s_mov_b32 s14, 4718592
s_mov_b32 s15, 0x20000
s_add_u32 s16, s16, 4194304
s_addc_u32 s17, s17, 0
s_mov_b32 s18, 16777216
s_mov_b32 s19, 0x20000
s_add_u32 s20, s20, 20971520
s_addc_u32 s21, s21, 0
s_mov_b32 s22, 16777216
s_mov_b32 s23, 0x20000
s_add_u32 s24, s24, 37814272
s_addc_u32 s25, s25, 0
s_mov_b32 s26, 16777216
s_mov_b32 s27, 0x20000
s_mov_b32 s30, 4718592
s_mov_b32 s31, 0x20000
s_mov_b32 s34, 18874368
s_mov_b32 s35, 0x20000
s_lshl_b32 s4, s2, 3
s_add_u32 s4, s4, s3
s_mov_b32 s79, 524288
s_mov_b64 s[28:29], s[28:29]
s_mov_b32 s30, s30
s_cmp_lt_u32 s4, 512
s_cbranch_scc1 .attn_pf
s_sub_u32 s4, s4, 512
s_mov_b32 s79, 1572864
s_mov_b64 s[28:29], s[32:33]
s_mov_b32 s30, s34
.attn_pf:
s_lshl_b32 s4, s4, 10
v_lshl_add_u32 v240, v0, 4, s4
s_mov_b32 s68, s62
s_mov_b32 s69, 0
s_mov_b32 s40, 9
s_mov_b32 s44, 9
s_mov_b32 s41, 0
s_mov_b32 s43, 0
s_mov_b32 s45, 49152
s_mov_b32 s46, s44
s_sub_u32 s44, s44, 1
s_cmp_gt_i32 s46, 0
s_cbranch_scc0 .attn_L3
s_add_u32 m0, s41, s53
s_nop 0
buffer_load_dwordx4 v16, s[8:11], s50 offen lds
.attn_L3:
s_cmp_gt_i32 s46, 0
s_cbranch_scc0 .attn_L4
s_add_u32 m0, m0, 1024
s_nop 0
buffer_load_dwordx4 v17, s[8:11], s50 offen lds
.attn_L4:
s_cmp_gt_i32 s46, 0
s_cbranch_scc0 .attn_L5
s_add_u32 m0, m0, 1024
s_nop 0
buffer_load_dwordx4 v18, s[8:11], s50 offen lds
.attn_L5:
s_cmp_gt_i32 s46, 0
s_cbranch_scc0 .attn_L6
s_add_u32 m0, m0, 1024
s_nop 0
buffer_load_dwordx4 v19, s[8:11], s50 offen lds
s_add_u32 s50, s50, 128
.attn_L6:
s_cmp_gt_i32 s46, 0
s_cbranch_scc0 .attn_L7
s_add_u32 m0, s41, s54
s_nop 0
buffer_load_dwordx4 v20, s[12:15], s51 offen lds
.attn_L7:
s_cmp_gt_i32 s46, 0
s_cbranch_scc0 .attn_L8
s_add_u32 m0, m0, 1024
s_nop 0
buffer_load_dwordx4 v21, s[12:15], s51 offen lds
s_add_u32 s51, s51, 524288
.attn_L8:
s_add_u32 s41, s41, 49152
s_cmp_eq_u32 s41, 147456
s_cselect_b32 s41, 0, s41
s_mov_b32 s46, s44
s_sub_u32 s44, s44, 1
s_cmp_gt_i32 s46, 0
s_cbranch_scc0 .attn_L9
s_add_u32 m0, s41, s53
s_nop 0
buffer_load_dwordx4 v16, s[8:11], s50 offen lds
.attn_L9:
s_cmp_gt_i32 s46, 0
s_cbranch_scc0 .attn_L10
s_add_u32 m0, m0, 1024
s_nop 0
buffer_load_dwordx4 v17, s[8:11], s50 offen lds
.attn_L10:
s_cmp_gt_i32 s46, 0
s_cbranch_scc0 .attn_L11
s_add_u32 m0, m0, 1024
s_nop 0
buffer_load_dwordx4 v18, s[8:11], s50 offen lds
.attn_L11:
s_cmp_gt_i32 s46, 0
s_cbranch_scc0 .attn_L12
s_add_u32 m0, m0, 1024
s_nop 0
buffer_load_dwordx4 v19, s[8:11], s50 offen lds
s_add_u32 s50, s50, 128
.attn_L12:
s_cmp_gt_i32 s46, 0
s_cbranch_scc0 .attn_L13
s_add_u32 m0, s41, s54
s_nop 0
buffer_load_dwordx4 v20, s[12:15], s51 offen lds
.attn_L13:
s_cmp_gt_i32 s46, 0
s_cbranch_scc0 .attn_L14
s_add_u32 m0, m0, 1024
s_nop 0
buffer_load_dwordx4 v21, s[12:15], s51 offen lds
s_add_u32 s51, s51, 524288
.attn_L14:
s_add_u32 s41, s41, 49152
s_cmp_eq_u32 s41, 147456
s_cselect_b32 s41, 0, s41
s_mov_b32 s46, s44
s_sub_u32 s44, s44, 1
s_cmp_gt_i32 s46, 0
s_cbranch_scc0 .attn_L15
s_add_u32 m0, s41, s53
s_nop 0
buffer_load_dwordx4 v16, s[8:11], s50 offen lds
.attn_L15:
s_cmp_gt_i32 s46, 0
s_cbranch_scc0 .attn_L16
s_add_u32 m0, m0, 1024
s_nop 0
buffer_load_dwordx4 v17, s[8:11], s50 offen lds
.attn_L16:
v_mov_b32 v112, 0
v_mov_b32 v113, 0
v_mov_b32 v114, 0
v_mov_b32 v115, 0
v_mov_b32 v116, 0
v_mov_b32 v117, 0
v_mov_b32 v118, 0
v_mov_b32 v119, 0
v_mov_b32 v120, 0
v_mov_b32 v121, 0
v_mov_b32 v122, 0
v_mov_b32 v123, 0
v_mov_b32 v124, 0
v_mov_b32 v125, 0
v_mov_b32 v126, 0
v_mov_b32 v127, 0
v_mov_b32 v128, 0
v_mov_b32 v129, 0
v_mov_b32 v130, 0
v_mov_b32 v131, 0
v_mov_b32 v132, 0
v_mov_b32 v133, 0
v_mov_b32 v134, 0
v_mov_b32 v135, 0
v_mov_b32 v136, 0
v_mov_b32 v137, 0
v_mov_b32 v138, 0
v_mov_b32 v139, 0
v_mov_b32 v140, 0
v_mov_b32 v141, 0
v_mov_b32 v142, 0
v_mov_b32 v143, 0
v_mov_b32 v144, 0
v_mov_b32 v145, 0
v_mov_b32 v146, 0
v_mov_b32 v147, 0
v_mov_b32 v148, 0
v_mov_b32 v149, 0
v_mov_b32 v150, 0
v_mov_b32 v151, 0
v_mov_b32 v152, 0
v_mov_b32 v153, 0
v_mov_b32 v154, 0
v_mov_b32 v155, 0
v_mov_b32 v156, 0
v_mov_b32 v157, 0
v_mov_b32 v158, 0
v_mov_b32 v159, 0
v_mov_b32 v160, 0
v_mov_b32 v161, 0
v_mov_b32 v162, 0
v_mov_b32 v163, 0
v_mov_b32 v164, 0
v_mov_b32 v165, 0
v_mov_b32 v166, 0
v_mov_b32 v167, 0
v_mov_b32 v168, 0
v_mov_b32 v169, 0
v_mov_b32 v170, 0
v_mov_b32 v171, 0
v_mov_b32 v172, 0
v_mov_b32 v173, 0
v_mov_b32 v174, 0
v_mov_b32 v175, 0
s_waitcnt vmcnt(8)
s_barrier
ds_read_b64_tr_b16 v[48:49], v26 offset:0
ds_read_b64_tr_b16 v[50:51], v26 offset:1024
ds_read_b64_tr_b16 v[52:53], v27 offset:0
ds_read_b64_tr_b16 v[54:55], v27 offset:1024
ds_read_b128 v[56:59], v22 offset:0
ds_read_b128 v[60:63], v22 offset:4096
.attn_L21:
ds_read_b64_tr_b16 v[64:65], v26 offset:4096
ds_read_b64_tr_b16 v[66:67], v26 offset:5120
ds_read_b64_tr_b16 v[68:69], v27 offset:4096
s_waitcnt lgkmcnt(3)
v_mfma_f32_32x32x16_bf16 v[112:127], v[48:51], v[56:59], v[112:127]
ds_read_b64_tr_b16 v[70:71], v27 offset:5120
v_mfma_f32_32x32x16_bf16 v[128:143], v[48:51], v[60:63], v[128:143]
s_cmp_gt_i32 s46, 0
s_cbranch_scc0 .attn_L24
s_add_u32 m0, m0, 1024
s_nop 0
buffer_load_dwordx4 v18, s[8:11], s50 offen lds
.attn_L24:
v_mfma_f32_32x32x16_bf16 v[144:159], v[52:55], v[56:59], v[144:159]
ds_read_b128 v[72:75], v23 offset:0
v_mfma_f32_32x32x16_bf16 v[160:175], v[52:55], v[60:63], v[160:175]
ds_read_b128 v[76:79], v23 offset:4096
s_cmp_gt_i32 s46, 0
s_cbranch_scc0 .attn_L25
s_add_u32 m0, m0, 1024
s_nop 0
buffer_load_dwordx4 v19, s[8:11], s50 offen lds
s_add_u32 s50, s50, 128
.attn_L25:
ds_read_b64_tr_b16 v[48:49], v26 offset:8192
ds_read_b64_tr_b16 v[50:51], v26 offset:9216
ds_read_b64_tr_b16 v[52:53], v27 offset:8192
s_waitcnt lgkmcnt(3)
v_mfma_f32_32x32x16_bf16 v[112:127], v[64:67], v[72:75], v[112:127]
ds_read_b64_tr_b16 v[54:55], v27 offset:9216
v_mfma_f32_32x32x16_bf16 v[128:143], v[64:67], v[76:79], v[128:143]
s_cmp_gt_i32 s46, 0
s_cbranch_scc0 .attn_L32
s_add_u32 m0, s41, s54
s_nop 0
buffer_load_dwordx4 v20, s[12:15], s51 offen lds
.attn_L32:
v_mfma_f32_32x32x16_bf16 v[144:159], v[68:71], v[72:75], v[144:159]
ds_read_b128 v[56:59], v24 offset:0
v_mfma_f32_32x32x16_bf16 v[160:175], v[68:71], v[76:79], v[160:175]
ds_read_b128 v[60:63], v24 offset:4096
s_cmp_gt_i32 s46, 0
s_cbranch_scc0 .attn_L33
s_add_u32 m0, m0, 1024
s_nop 0
buffer_load_dwordx4 v21, s[12:15], s51 offen lds
s_add_u32 s51, s51, 524288
.attn_L33:
s_add_u32 s41, s41, 49152
s_cmp_eq_u32 s41, 147456
s_cselect_b32 s41, 0, s41
ds_read_b64_tr_b16 v[64:65], v26 offset:12288
ds_read_b64_tr_b16 v[66:67], v26 offset:13312
ds_read_b64_tr_b16 v[68:69], v27 offset:12288
s_waitcnt lgkmcnt(3)
v_mfma_f32_32x32x16_bf16 v[112:127], v[48:51], v[56:59], v[112:127]
v_mfma_f32_32x32x16_bf16 v[128:143], v[48:51], v[60:63], v[128:143]
ds_read_b64_tr_b16 v[70:71], v27 offset:13312
v_mfma_f32_32x32x16_bf16 v[144:159], v[52:55], v[56:59], v[144:159]
ds_read_b128 v[72:75], v25 offset:0
v_mfma_f32_32x32x16_bf16 v[160:175], v[52:55], v[60:63], v[160:175]
ds_read_b128 v[76:79], v25 offset:4096
s_add_u32 s43, s43, 49152
s_cmp_eq_u32 s43, 147456
s_cselect_b32 s42, -98304, s45
s_cselect_b32 s43, 0, s43
s_waitcnt lgkmcnt(0)
v_add_u32 v26, s42, v26
v_add_u32 v27, s42, v27
v_add_u32 v22, s42, v22
v_add_u32 v23, s42, v23
v_add_u32 v24, s42, v24
v_add_u32 v25, s42, v25
s_waitcnt vmcnt(6)
s_cmp_eq_u32 s40, 2
s_cbranch_scc0 .attn_L34
s_waitcnt vmcnt(4)
.attn_L34:
s_barrier
v_mfma_f32_32x32x16_bf16 v[112:127], v[64:67], v[72:75], v[112:127]
ds_read_b64_tr_b16 v[48:49], v26 offset:0
ds_read_b64_tr_b16 v[50:51], v26 offset:1024
ds_read_b64_tr_b16 v[52:53], v27 offset:0
v_mfma_f32_32x32x16_bf16 v[128:143], v[64:67], v[76:79], v[128:143]
ds_read_b64_tr_b16 v[54:55], v27 offset:1024
s_cmp_eq_u32 s40, 3
s_cbranch_scc0 .attn_L1
s_mov_b32 s66, s64
s_mov_b32 s67, s64
s_mov_b32 s18, 0x1000000
s_add_u32 m0, s63, 0
s_nop 0
buffer_load_dwordx4 v10, s[16:19], s66 offen offset:0 lds
buffer_load_dwordx4 v10, s[16:19], s66 offen offset:1024 lds
buffer_load_dwordx4 v10, s[16:19], s66 offen offset:2048 lds
buffer_load_dwordx4 v10, s[16:19], s66 offen offset:3072 lds
s_add_u32 s66, s66, 32768
.attn_L1:
s_cmp_eq_u32 s40, 2
s_cbranch_scc0 .attn_L2
s_cmp_gt_u32 s68, 0
s_cselect_b32 s18, s18, 0
s_add_u32 m0, s63, 32768
s_nop 0
buffer_load_dwordx4 v10, s[16:19], s66 offen offset:0 lds
buffer_load_dwordx4 v10, s[16:19], s66 offen offset:1024 lds
buffer_load_dwordx4 v10, s[16:19], s66 offen offset:2048 lds
buffer_load_dwordx4 v10, s[16:19], s66 offen offset:3072 lds
s_add_u32 s66, s66, 32768
s_add_u32 m0, s65, 0
s_nop 0
buffer_load_dwordx4 v10, s[20:23], s67 offen offset:0 lds
buffer_load_dwordx4 v10, s[20:23], s67 offen offset:1024 lds
buffer_load_dwordx4 v10, s[20:23], s67 offen offset:2048 lds
buffer_load_dwordx4 v10, s[20:23], s67 offen offset:3072 lds
s_add_u32 s67, s67, 32768
.attn_L2:
v_mfma_f32_32x32x16_bf16 v[144:159], v[68:71], v[72:75], v[144:159]
ds_read_b128 v[56:59], v22 offset:0
s_mov_b32 s46, s44
s_sub_u32 s44, s44, 1
s_cmp_gt_i32 s46, 0
s_cbranch_scc0 .attn_L35
s_add_u32 m0, s41, s53
s_nop 0
buffer_load_dwordx4 v16, s[8:11], s50 offen lds
.attn_L35:
v_mfma_f32_32x32x16_bf16 v[160:175], v[68:71], v[76:79], v[160:175]
ds_read_b128 v[60:63], v22 offset:4096
s_cmp_gt_i32 s46, 0
s_cbranch_scc0 .attn_L36
s_add_u32 m0, m0, 1024
s_nop 0
buffer_load_dwordx4 v17, s[8:11], s50 offen lds
.attn_L36:
s_sub_u32 s40, s40, 1
s_cmp_lg_u32 s40, 0
s_cbranch_scc1 .attn_L21
s_waitcnt lgkmcnt(0)
s_nop 7
s_nop 7
s_barrier
s_lshl_b32 s4, s56, 13
s_lshl_b32 s5, s57, 11
s_add_u32 s4, s4, s5
s_add_u32 s4, s4, 0x18000
v_lshl_add_u32 v1, v0, 4, s4
s_mov_b32 s4, 0x3e0293ee
v_mul_f32 v112, s4, v112
v_mul_f32 v113, s4, v113
v_mul_f32 v114, s4, v114
v_mul_f32 v115, s4, v115
v_mul_f32 v116, s4, v116
v_mul_f32 v117, s4, v117
v_mul_f32 v118, s4, v118
v_mul_f32 v119, s4, v119
v_mul_f32 v120, s4, v120
v_mul_f32 v121, s4, v121
v_mul_f32 v122, s4, v122
v_mul_f32 v123, s4, v123
v_mul_f32 v124, s4, v124
v_mul_f32 v125, s4, v125
v_mul_f32 v126, s4, v126
v_mul_f32 v127, s4, v127
v_cvt_pk_bf16_f32 v48, v112, v113
v_cvt_pk_bf16_f32 v49, v114, v115
v_cvt_pk_bf16_f32 v50, v116, v117
v_cvt_pk_bf16_f32 v51, v118, v119
ds_write_b128 v1, v[48:51] offset:0
v_cvt_pk_bf16_f32 v52, v120, v121
v_cvt_pk_bf16_f32 v53, v122, v123
v_cvt_pk_bf16_f32 v54, v124, v125
v_cvt_pk_bf16_f32 v55, v126, v127
ds_write_b128 v1, v[52:55] offset:1024
v_mul_f32 v128, s4, v128
v_mul_f32 v129, s4, v129
v_mul_f32 v130, s4, v130
v_mul_f32 v131, s4, v131
v_mul_f32 v132, s4, v132
v_mul_f32 v133, s4, v133
v_mul_f32 v134, s4, v134
v_mul_f32 v135, s4, v135
v_mul_f32 v136, s4, v136
v_mul_f32 v137, s4, v137
v_mul_f32 v138, s4, v138
v_mul_f32 v139, s4, v139
v_mul_f32 v140, s4, v140
v_mul_f32 v141, s4, v141
v_mul_f32 v142, s4, v142
v_mul_f32 v143, s4, v143
v_cvt_pk_bf16_f32 v56, v128, v129
v_cvt_pk_bf16_f32 v57, v130, v131
v_cvt_pk_bf16_f32 v58, v132, v133
v_cvt_pk_bf16_f32 v59, v134, v135
ds_write_b128 v1, v[56:59] offset:8192
v_cvt_pk_bf16_f32 v60, v136, v137
v_cvt_pk_bf16_f32 v61, v138, v139
v_cvt_pk_bf16_f32 v62, v140, v141
v_cvt_pk_bf16_f32 v63, v142, v143
ds_write_b128 v1, v[60:63] offset:9216
v_mul_f32 v144, s4, v144
v_mul_f32 v145, s4, v145
v_mul_f32 v146, s4, v146
v_mul_f32 v147, s4, v147
v_mul_f32 v148, s4, v148
v_mul_f32 v149, s4, v149
v_mul_f32 v150, s4, v150
v_mul_f32 v151, s4, v151
v_mul_f32 v152, s4, v152
v_mul_f32 v153, s4, v153
v_mul_f32 v154, s4, v154
v_mul_f32 v155, s4, v155
v_mul_f32 v156, s4, v156
v_mul_f32 v157, s4, v157
v_mul_f32 v158, s4, v158
v_mul_f32 v159, s4, v159
v_cvt_pk_bf16_f32 v64, v144, v145
v_cvt_pk_bf16_f32 v65, v146, v147
v_cvt_pk_bf16_f32 v66, v148, v149
v_cvt_pk_bf16_f32 v67, v150, v151
ds_write_b128 v1, v[64:67] offset:2048
v_cvt_pk_bf16_f32 v68, v152, v153
v_cvt_pk_bf16_f32 v69, v154, v155
v_cvt_pk_bf16_f32 v70, v156, v157
v_cvt_pk_bf16_f32 v71, v158, v159
ds_write_b128 v1, v[68:71] offset:3072
v_mul_f32 v160, s4, v160
v_mul_f32 v161, s4, v161
v_mul_f32 v162, s4, v162
v_mul_f32 v163, s4, v163
v_mul_f32 v164, s4, v164
v_mul_f32 v165, s4, v165
v_mul_f32 v166, s4, v166
v_mul_f32 v167, s4, v167
v_mul_f32 v168, s4, v168
v_mul_f32 v169, s4, v169
v_mul_f32 v170, s4, v170
v_mul_f32 v171, s4, v171
v_mul_f32 v172, s4, v172
v_mul_f32 v173, s4, v173
v_mul_f32 v174, s4, v174
v_mul_f32 v175, s4, v175
v_cvt_pk_bf16_f32 v72, v160, v161
v_cvt_pk_bf16_f32 v73, v162, v163
v_cvt_pk_bf16_f32 v74, v164, v165
v_cvt_pk_bf16_f32 v75, v166, v167
ds_write_b128 v1, v[72:75] offset:10240
v_cvt_pk_bf16_f32 v76, v168, v169
v_cvt_pk_bf16_f32 v77, v170, v171
v_cvt_pk_bf16_f32 v78, v172, v173
v_cvt_pk_bf16_f32 v79, v174, v175
ds_write_b128 v1, v[76:79] offset:11264
s_lshl_b32 s4, s61, 13
s_add_u32 s4, s4, 0x18000
v_lshl_add_u32 v15, v0, 4, s4
v_and_b32 v1, 31, v0
v_lshrrev_b32 v2, 5, v0
v_lshlrev_b32 v2, 2, v2
s_lshl_b32 s4, s61, 5
s_lshl_b32 s5, s60, 6
s_sub_u32 s4, s4, s5
v_add_u32 v1, s4, v1
v_sub_u32 v11, v1, v2
s_waitcnt lgkmcnt(0)
s_barrier
s_waitcnt vmcnt(8)
.attn_B41:
ds_read_b128 v[16:19], v15 offset:0
ds_read_b128 v[20:23], v15 offset:1024
ds_read_b128 v[24:27], v15 offset:2048
ds_read_b128 v[28:31], v15 offset:3072
ds_read_b128 v[32:35], v15 offset:4096
ds_read_b128 v[36:39], v15 offset:5120
ds_read_b128 v[40:43], v15 offset:6144
ds_read_b128 v[44:47], v15 offset:7168
v_mov_b32 v48, 0
v_mov_b32 v49, 0
v_mov_b32 v50, 0
v_mov_b32 v51, 0
v_mov_b32 v52, 0
v_mov_b32 v53, 0
v_mov_b32 v54, 0
v_mov_b32 v55, 0
v_mov_b32 v56, 0
v_mov_b32 v57, 0
v_mov_b32 v58, 0
v_mov_b32 v59, 0
v_mov_b32 v60, 0
v_mov_b32 v61, 0
v_mov_b32 v62, 0
v_mov_b32 v63, 0
v_mov_b32 v64, 0
v_mov_b32 v65, 0
v_mov_b32 v66, 0
v_mov_b32 v67, 0
v_mov_b32 v68, 0
v_mov_b32 v69, 0
v_mov_b32 v70, 0
v_mov_b32 v71, 0
v_mov_b32 v72, 0
v_mov_b32 v73, 0
v_mov_b32 v74, 0
v_mov_b32 v75, 0
v_mov_b32 v76, 0
v_mov_b32 v77, 0
v_mov_b32 v78, 0
v_mov_b32 v79, 0
v_mov_b32 v80, 0
v_mov_b32 v81, 0
v_mov_b32 v82, 0
v_mov_b32 v83, 0
v_mov_b32 v84, 0
v_mov_b32 v85, 0
v_mov_b32 v86, 0
v_mov_b32 v87, 0
v_mov_b32 v88, 0
v_mov_b32 v89, 0
v_mov_b32 v90, 0
v_mov_b32 v91, 0
v_mov_b32 v92, 0
v_mov_b32 v93, 0
v_mov_b32 v94, 0
v_mov_b32 v95, 0
v_mov_b32 v96, 0
v_mov_b32 v97, 0
v_mov_b32 v98, 0
v_mov_b32 v99, 0
v_mov_b32 v100, 0
v_mov_b32 v101, 0
v_mov_b32 v102, 0
v_mov_b32 v103, 0
v_mov_b32 v104, 0
v_mov_b32 v105, 0
v_mov_b32 v106, 0
v_mov_b32 v107, 0
v_mov_b32 v108, 0
v_mov_b32 v109, 0
v_mov_b32 v110, 0
v_mov_b32 v111, 0
v_mov_b32 v12, 0
v_mov_b32 v13, 0
s_barrier
s_cmp_eq_u32 s69, 0
s_cbranch_scc0 .attn_t2
.attn_t2:
ds_read_b128 v[208:211], v8 offset:0
ds_read_b128 v[212:215], v8 offset:1024
ds_read_b128 v[216:219], v8 offset:2048
ds_read_b128 v[220:223], v8 offset:3072
s_waitcnt lgkmcnt(4)
ds_read_b128 v[224:227], v8 offset:4096
s_waitcnt lgkmcnt(4)
v_mfma_f32_32x32x16_bf16 v[112:127], v[208:211], v[16:19], 0
ds_read_b128 v[228:231], v8 offset:5120
s_waitcnt lgkmcnt(4)
v_mfma_f32_32x32x16_bf16 v[112:127], v[212:215], v[20:23], v[112:127]
ds_read_b128 v[232:235], v8 offset:6144
s_waitcnt lgkmcnt(4)
v_mfma_f32_32x32x16_bf16 v[112:127], v[216:219], v[24:27], v[112:127]
ds_read_b128 v[236:239], v8 offset:7168
s_waitcnt lgkmcnt(4)
v_mfma_f32_32x32x16_bf16 v[112:127], v[220:223], v[28:31], v[112:127]
ds_read_b128 v[208:211], v8 offset:8192
s_waitcnt lgkmcnt(4)
v_mfma_f32_32x32x16_bf16 v[112:127], v[224:227], v[32:35], v[112:127]
ds_read_b128 v[212:215], v8 offset:9216
s_waitcnt lgkmcnt(4)
v_mfma_f32_32x32x16_bf16 v[112:127], v[228:231], v[36:39], v[112:127]
ds_read_b128 v[216:219], v8 offset:10240
s_waitcnt lgkmcnt(4)
v_mfma_f32_32x32x16_bf16 v[112:127], v[232:235], v[40:43], v[112:127]
ds_read_b128 v[220:223], v8 offset:11264
s_waitcnt lgkmcnt(4)
v_mfma_f32_32x32x16_bf16 v[112:127], v[236:239], v[44:47], v[112:127]
ds_read_b128 v[224:227], v8 offset:12288
s_waitcnt lgkmcnt(4)
v_mfma_f32_32x32x16_bf16 v[128:143], v[208:211], v[16:19], 0
ds_read_b128 v[228:231], v8 offset:13312
s_waitcnt lgkmcnt(4)
v_mfma_f32_32x32x16_bf16 v[128:143], v[212:215], v[20:23], v[128:143]
ds_read_b128 v[232:235], v8 offset:14336
s_waitcnt lgkmcnt(4)
v_mfma_f32_32x32x16_bf16 v[128:143], v[216:219], v[24:27], v[128:143]
ds_read_b128 v[236:239], v8 offset:15360
s_waitcnt lgkmcnt(4)
v_mfma_f32_32x32x16_bf16 v[128:143], v[220:223], v[28:31], v[128:143]
s_waitcnt lgkmcnt(3)
v_mfma_f32_32x32x16_bf16 v[128:143], v[224:227], v[32:35], v[128:143]
s_waitcnt lgkmcnt(2)
v_mfma_f32_32x32x16_bf16 v[128:143], v[228:231], v[36:39], v[128:143]
s_waitcnt lgkmcnt(1)
v_mfma_f32_32x32x16_bf16 v[128:143], v[232:235], v[40:43], v[128:143]
s_waitcnt lgkmcnt(0)
v_mfma_f32_32x32x16_bf16 v[128:143], v[236:239], v[44:47], v[128:143]
s_cmp_lg_u32 s68, 0
s_cbranch_scc1 .attn_L42
s_nop 7
s_nop 4
v_mov_b32 v7, 0xf149f2ca
v_cmp_gt_i32 s[70:71], 0, v11
v_cmp_gt_i32 s[72:73], 1, v11
v_cmp_gt_i32 s[74:75], 2, v11
v_cmp_gt_i32 s[76:77], 3, v11
v_cndmask_b32 v112, v112, v7, s[70:71]
v_cndmask_b32 v113, v113, v7, s[72:73]
v_cndmask_b32 v114, v114, v7, s[74:75]
v_cndmask_b32 v115, v115, v7, s[76:77]
v_cmp_gt_i32 s[70:71], 8, v11
v_cmp_gt_i32 s[72:73], 9, v11
v_cmp_gt_i32 s[74:75], 10, v11
v_cmp_gt_i32 s[76:77], 11, v11
v_cndmask_b32 v116, v116, v7, s[70:71]
v_cndmask_b32 v117, v117, v7, s[72:73]
v_cndmask_b32 v118, v118, v7, s[74:75]
v_cndmask_b32 v119, v119, v7, s[76:77]
v_cmp_gt_i32 s[70:71], 16, v11
v_cmp_gt_i32 s[72:73], 17, v11
v_cmp_gt_i32 s[74:75], 18, v11
v_cmp_gt_i32 s[76:77], 19, v11
v_cndmask_b32 v120, v120, v7, s[70:71]
v_cndmask_b32 v121, v121, v7, s[72:73]
v_cndmask_b32 v122, v122, v7, s[74:75]
v_cndmask_b32 v123, v123, v7, s[76:77]
v_cmp_gt_i32 s[70:71], 24, v11
v_cmp_gt_i32 s[72:73], 25, v11
v_cmp_gt_i32 s[74:75], 26, v11
v_cmp_gt_i32 s[76:77], 27, v11
v_cndmask_b32 v124, v124, v7, s[70:71]
v_cndmask_b32 v125, v125, v7, s[72:73]
v_cndmask_b32 v126, v126, v7, s[74:75]
v_cndmask_b32 v127, v127, v7, s[76:77]
v_cmp_gt_i32 s[70:71], 32, v11
v_cmp_gt_i32 s[72:73], 33, v11
v_cmp_gt_i32 s[74:75], 34, v11
v_cmp_gt_i32 s[76:77], 35, v11
v_cndmask_b32 v128, v128, v7, s[70:71]
v_cndmask_b32 v129, v129, v7, s[72:73]
v_cndmask_b32 v130, v130, v7, s[74:75]
v_cndmask_b32 v131, v131, v7, s[76:77]
v_cmp_gt_i32 s[70:71], 40, v11
v_cmp_gt_i32 s[72:73], 41, v11
v_cmp_gt_i32 s[74:75], 42, v11
v_cmp_gt_i32 s[76:77], 43, v11
v_cndmask_b32 v132, v132, v7, s[70:71]
v_cndmask_b32 v133, v133, v7, s[72:73]
v_cndmask_b32 v134, v134, v7, s[74:75]
v_cndmask_b32 v135, v135, v7, s[76:77]
v_cmp_gt_i32 s[70:71], 48, v11
v_cmp_gt_i32 s[72:73], 49, v11
v_cmp_gt_i32 s[74:75], 50, v11
v_cmp_gt_i32 s[76:77], 51, v11
v_cndmask_b32 v136, v136, v7, s[70:71]
v_cndmask_b32 v137, v137, v7, s[72:73]
v_cndmask_b32 v138, v138, v7, s[74:75]
v_cndmask_b32 v139, v139, v7, s[76:77]
v_cmp_gt_i32 s[70:71], 56, v11
v_cmp_gt_i32 s[72:73], 57, v11
v_cmp_gt_i32 s[74:75], 58, v11
v_cmp_gt_i32 s[76:77], 59, v11
v_cndmask_b32 v140, v140, v7, s[70:71]
v_cndmask_b32 v141, v141, v7, s[72:73]
v_cndmask_b32 v142, v142, v7, s[74:75]
v_cndmask_b32 v143, v143, v7, s[76:77]
.attn_L42:
s_nop 7
s_nop 4
v_max3_f32 v14, v112, v113, v114
v_max3_f32 v6, v115, v116, v117
v_max3_f32 v14, v14, v118, v119
v_max3_f32 v6, v6, v120, v121
v_max3_f32 v14, v14, v122, v123
v_max3_f32 v6, v6, v124, v125
v_max3_f32 v14, v14, v126, v127
v_max3_f32 v6, v6, v128, v129
v_max3_f32 v14, v14, v130, v131
v_max3_f32 v6, v6, v132, v133
v_max3_f32 v14, v14, v134, v135
v_max3_f32 v6, v6, v136, v137
v_max3_f32 v14, v14, v138, v139
v_max3_f32 v6, v6, v140, v141
v_max3_f32 v14, v14, v142, v143
v_max_f32 v14, v14, v6
v_mov_b32 v6, v14
s_nop 1
v_permlane32_swap_b32 v6, v14
s_nop 1
v_max_f32 v14, v14, v6
v_sub_f32 v112, v112, v14
v_sub_f32 v113, v113, v14
v_sub_f32 v114, v114, v14
v_sub_f32 v115, v115, v14
v_sub_f32 v116, v116, v14
v_sub_f32 v117, v117, v14
v_sub_f32 v118, v118, v14
v_sub_f32 v119, v119, v14
v_sub_f32 v120, v120, v14
v_sub_f32 v121, v121, v14
v_sub_f32 v122, v122, v14
v_sub_f32 v123, v123, v14
v_sub_f32 v124, v124, v14
v_sub_f32 v125, v125, v14
v_sub_f32 v126, v126, v14
v_sub_f32 v127, v127, v14
v_sub_f32 v128, v128, v14
v_sub_f32 v129, v129, v14
v_sub_f32 v130, v130, v14
v_sub_f32 v131, v131, v14
v_sub_f32 v132, v132, v14
v_sub_f32 v133, v133, v14
v_sub_f32 v134, v134, v14
v_sub_f32 v135, v135, v14
v_sub_f32 v136, v136, v14
v_sub_f32 v137, v137, v14
v_sub_f32 v138, v138, v14
v_sub_f32 v139, v139, v14
v_sub_f32 v140, v140, v14
v_sub_f32 v141, v141, v14
v_sub_f32 v142, v142, v14
v_sub_f32 v143, v143, v14
v_sub_f32 v192, 0, v14
v_sub_f32 v193, 0, v14
v_sub_f32 v194, 0, v14
v_sub_f32 v195, 0, v14
v_sub_f32 v196, 0, v14
v_sub_f32 v197, 0, v14
v_sub_f32 v198, 0, v14
v_sub_f32 v199, 0, v14
v_sub_f32 v200, 0, v14
v_sub_f32 v201, 0, v14
v_sub_f32 v202, 0, v14
v_sub_f32 v203, 0, v14
v_sub_f32 v204, 0, v14
v_sub_f32 v205, 0, v14
v_sub_f32 v206, 0, v14
v_sub_f32 v207, 0, v14
s_waitcnt vmcnt(4)
s_barrier
ds_read_b128 v[208:211], v8 offset:32768
ds_read_b128 v[212:215], v8 offset:33792
ds_read_b128 v[216:219], v8 offset:34816
ds_read_b128 v[220:223], v8 offset:35840
.attn_P43:
s_cmp_eq_u32 s68, 0
s_cbranch_scc1 .attn_T45
s_cmp_gt_u32 s68, 1
s_cselect_b32 s18, s18, 0
ds_read_b128 v[224:227], v8 offset:36864
s_waitcnt lgkmcnt(4)
v_mfma_f32_32x32x16_bf16 v[144:159], v[208:211], v[16:19], v[192:207]
v_exp_f32 v112, v112
v_exp_f32 v113, v113
v_exp_f32 v114, v114
ds_read_b128 v[228:231], v8 offset:37888
s_waitcnt lgkmcnt(4)
v_mfma_f32_32x32x16_bf16 v[144:159], v[212:215], v[20:23], v[144:159]
s_add_u32 m0, s63, 0
s_nop 0
buffer_load_dwordx4 v10, s[16:19], s66 offen offset:0 lds
v_exp_f32 v115, v115
v_exp_f32 v116, v116
v_exp_f32 v117, v117
ds_read_b128 v[232:235], v8 offset:38912
s_waitcnt lgkmcnt(4)
v_mfma_f32_32x32x16_bf16 v[144:159], v[216:219], v[24:27], v[144:159]
v_exp_f32 v118, v118
v_exp_f32 v119, v119
v_exp_f32 v120, v120
ds_read_b128 v[236:239], v8 offset:39936
s_waitcnt lgkmcnt(4)
v_mfma_f32_32x32x16_bf16 v[144:159], v[220:223], v[28:31], v[144:159]
v_exp_f32 v121, v121
v_cvt_pk_bf16_f32 v176, v112, v113
v_cvt_pk_bf16_f32 v177, v114, v115
v_cvt_pk_bf16_f32 v178, v116, v117
ds_read_b128 v[208:211], v8 offset:40960
s_waitcnt lgkmcnt(4)
v_mfma_f32_32x32x16_bf16 v[144:159], v[224:227], v[32:35], v[144:159]
buffer_load_dwordx4 v10, s[16:19], s66 offen offset:1024 lds
v_cvt_pk_bf16_f32 v179, v118, v119
v_exp_f32 v122, v122
v_exp_f32 v123, v123
ds_read_b128 v[212:215], v8 offset:41984
s_waitcnt lgkmcnt(4)
v_mfma_f32_32x32x16_bf16 v[144:159], v[228:231], v[36:39], v[144:159]
v_exp_f32 v124, v124
v_exp_f32 v125, v125
v_exp_f32 v126, v126
ds_read_b128 v[216:219], v8 offset:43008
s_waitcnt lgkmcnt(4)
v_mfma_f32_32x32x16_bf16 v[144:159], v[232:235], v[40:43], v[144:159]
v_exp_f32 v127, v127
v_add_f32 v12, v12, v112
v_add_f32 v13, v13, v113
ds_read_b128 v[220:223], v8 offset:44032
s_waitcnt lgkmcnt(4)
v_mfma_f32_32x32x16_bf16 v[144:159], v[236:239], v[44:47], v[144:159]
buffer_load_dwordx4 v10, s[16:19], s66 offen offset:2048 lds
v_cvt_pk_bf16_f32 v180, v120, v121
v_cvt_pk_bf16_f32 v181, v122, v123
v_cvt_pk_bf16_f32 v182, v124, v125
v_cvt_pk_bf16_f32 v183, v126, v127
ds_read_b128 v[224:227], v8 offset:45056
s_waitcnt lgkmcnt(4)
v_mfma_f32_32x32x16_bf16 v[160:175], v[208:211], v[16:19], v[192:207]
v_add_f32 v12, v12, v114
v_add_f32 v13, v13, v115
v_add_f32 v12, v12, v116
ds_read_b128 v[228:231], v8 offset:46080
s_waitcnt lgkmcnt(4)
v_mfma_f32_32x32x16_bf16 v[160:175], v[212:215], v[20:23], v[160:175]
v_add_f32 v13, v13, v117
v_add_f32 v12, v12, v118
v_add_f32 v13, v13, v119
ds_read_b128 v[232:235], v8 offset:47104
s_waitcnt lgkmcnt(4)
v_mfma_f32_32x32x16_bf16 v[160:175], v[216:219], v[24:27], v[160:175]
buffer_load_dwordx4 v10, s[16:19], s66 offen offset:3072 lds
s_add_u32 s66, s66, 32768
v_exp_f32 v128, v128
v_exp_f32 v129, v129
v_exp_f32 v130, v130
ds_read_b128 v[236:239], v8 offset:48128
s_waitcnt lgkmcnt(4)
v_mfma_f32_32x32x16_bf16 v[160:175], v[220:223], v[28:31], v[160:175]
v_exp_f32 v131, v131
v_exp_f32 v132, v132
v_exp_f32 v133, v133
v_exp_f32 v134, v134
buffer_load_dword v241, v240, s[28:31], 0 offen
v_add_u32 v240, s79, v240
s_waitcnt vmcnt(5)
s_barrier
ds_read_b128 v[208:211], v9 offset:0
s_waitcnt lgkmcnt(4)
v_mfma_f32_32x32x16_bf16 v[160:175], v[224:227], v[32:35], v[160:175]
v_exp_f32 v135, v135
v_add_f32 v12, v12, v120
v_add_f32 v13, v13, v121
ds_read_b128 v[212:215], v9 offset:2048
s_waitcnt lgkmcnt(4)
v_mfma_f32_32x32x16_bf16 v[160:175], v[228:231], v[36:39], v[160:175]
v_cvt_pk_bf16_f32 v184, v128, v129
v_cvt_pk_bf16_f32 v185, v130, v131
v_cvt_pk_bf16_f32 v186, v132, v133
ds_read_b128 v[216:219], v9 offset:4096
s_waitcnt lgkmcnt(4)
v_mfma_f32_32x32x16_bf16 v[160:175], v[232:235], v[40:43], v[160:175]
v_cvt_pk_bf16_f32 v187, v134, v135
v_add_f32 v12, v12, v122
v_add_f32 v13, v13, v123
ds_read_b128 v[220:223], v9 offset:6144
s_waitcnt lgkmcnt(4)
v_mfma_f32_32x32x16_bf16 v[160:175], v[236:239], v[44:47], v[160:175]
v_add_f32 v12, v12, v124
v_add_f32 v13, v13, v125
v_add_f32 v12, v12, v126
v_add_f32 v13, v13, v127
s_cmp_lg_u32 s68, 1
s_cbranch_scc1 .attn_L48
s_nop 7
s_nop 4
v_mov_b32 v7, 0xf149f2ca
v_cmp_gt_i32 s[70:71], 0, v11
v_cmp_gt_i32 s[72:73], 1, v11
v_cmp_gt_i32 s[74:75], 2, v11
v_cmp_gt_i32 s[76:77], 3, v11
v_cndmask_b32 v144, v144, v7, s[70:71]
v_cndmask_b32 v145, v145, v7, s[72:73]
v_cndmask_b32 v146, v146, v7, s[74:75]
v_cndmask_b32 v147, v147, v7, s[76:77]
v_cmp_gt_i32 s[70:71], 8, v11
v_cmp_gt_i32 s[72:73], 9, v11
v_cmp_gt_i32 s[74:75], 10, v11
v_cmp_gt_i32 s[76:77], 11, v11
v_cndmask_b32 v148, v148, v7, s[70:71]
v_cndmask_b32 v149, v149, v7, s[72:73]
v_cndmask_b32 v150, v150, v7, s[74:75]
v_cndmask_b32 v151, v151, v7, s[76:77]
v_cmp_gt_i32 s[70:71], 16, v11
v_cmp_gt_i32 s[72:73], 17, v11
v_cmp_gt_i32 s[74:75], 18, v11
v_cmp_gt_i32 s[76:77], 19, v11
v_cndmask_b32 v152, v152, v7, s[70:71]
v_cndmask_b32 v153, v153, v7, s[72:73]
v_cndmask_b32 v154, v154, v7, s[74:75]
v_cndmask_b32 v155, v155, v7, s[76:77]
v_cmp_gt_i32 s[70:71], 24, v11
v_cmp_gt_i32 s[72:73], 25, v11
v_cmp_gt_i32 s[74:75], 26, v11
v_cmp_gt_i32 s[76:77], 27, v11
v_cndmask_b32 v156, v156, v7, s[70:71]
v_cndmask_b32 v157, v157, v7, s[72:73]
v_cndmask_b32 v158, v158, v7, s[74:75]
v_cndmask_b32 v159, v159, v7, s[76:77]
v_cmp_gt_i32 s[70:71], 32, v11
v_cmp_gt_i32 s[72:73], 33, v11
v_cmp_gt_i32 s[74:75], 34, v11
v_cmp_gt_i32 s[76:77], 35, v11
v_cndmask_b32 v160, v160, v7, s[70:71]
v_cndmask_b32 v161, v161, v7, s[72:73]
v_cndmask_b32 v162, v162, v7, s[74:75]
v_cndmask_b32 v163, v163, v7, s[76:77]
v_cmp_gt_i32 s[70:71], 40, v11
v_cmp_gt_i32 s[72:73], 41, v11
v_cmp_gt_i32 s[74:75], 42, v11
v_cmp_gt_i32 s[76:77], 43, v11
v_cndmask_b32 v164, v164, v7, s[70:71]
v_cndmask_b32 v165, v165, v7, s[72:73]
v_cndmask_b32 v166, v166, v7, s[74:75]
v_cndmask_b32 v167, v167, v7, s[76:77]
v_cmp_gt_i32 s[70:71], 48, v11
v_cmp_gt_i32 s[72:73], 49, v11
v_cmp_gt_i32 s[74:75], 50, v11
v_cmp_gt_i32 s[76:77], 51, v11
v_cndmask_b32 v168, v168, v7, s[70:71]
v_cndmask_b32 v169, v169, v7, s[72:73]
v_cndmask_b32 v170, v170, v7, s[74:75]
v_cndmask_b32 v171, v171, v7, s[76:77]
v_cmp_gt_i32 s[70:71], 56, v11
v_cmp_gt_i32 s[72:73], 57, v11
v_cmp_gt_i32 s[74:75], 58, v11
v_cmp_gt_i32 s[76:77], 59, v11
v_cndmask_b32 v172, v172, v7, s[70:71]
v_cndmask_b32 v173, v173, v7, s[72:73]
v_cndmask_b32 v174, v174, v7, s[74:75]
v_cndmask_b32 v175, v175, v7, s[76:77]
.attn_L48:
ds_read_b128 v[224:227], v9 offset:1024
s_waitcnt lgkmcnt(4)
v_mfma_f32_32x32x16_bf16 v[48:63], v[208:211], v[176:179], v[48:63]
v_exp_f32 v136, v136
v_exp_f32 v137, v137
ds_read_b128 v[228:231], v9 offset:3072
s_waitcnt lgkmcnt(4)
v_mfma_f32_32x32x16_bf16 v[64:79], v[212:215], v[176:179], v[64:79]
s_add_u32 m0, s65, 32768
s_nop 0
buffer_load_dwordx4 v10, s[20:23], s67 offen offset:0 lds
v_exp_f32 v138, v138
v_exp_f32 v139, v139
ds_read_b128 v[232:235], v9 offset:5120
s_waitcnt lgkmcnt(4)
v_mfma_f32_32x32x16_bf16 v[80:95], v[216:219], v[176:179], v[80:95]
v_exp_f32 v140, v140
v_exp_f32 v141, v141
v_exp_f32 v142, v142
ds_read_b128 v[236:239], v9 offset:7168
s_waitcnt lgkmcnt(4)
v_mfma_f32_32x32x16_bf16 v[96:111], v[220:223], v[176:179], v[96:111]
v_exp_f32 v143, v143
v_add_f32 v12, v12, v128
ds_read_b128 v[208:211], v9 offset:8192
s_waitcnt lgkmcnt(4)
v_mfma_f32_32x32x16_bf16 v[48:63], v[224:227], v[180:183], v[48:63]
buffer_load_dwordx4 v10, s[20:23], s67 offen offset:1024 lds
v_add_f32 v13, v13, v129
v_cvt_pk_bf16_f32 v188, v136, v137
ds_read_b128 v[212:215], v9 offset:10240
s_waitcnt lgkmcnt(4)
v_mfma_f32_32x32x16_bf16 v[64:79], v[228:231], v[180:183], v[64:79]
v_cvt_pk_bf16_f32 v189, v138, v139
v_cvt_pk_bf16_f32 v190, v140, v141
v_cvt_pk_bf16_f32 v191, v142, v143
v_max3_f32 v14, v144, v145, v146
ds_read_b128 v[216:219], v9 offset:12288
s_waitcnt lgkmcnt(4)
v_mfma_f32_32x32x16_bf16 v[80:95], v[232:235], v[180:183], v[80:95]
v_add_f32 v12, v12, v130
v_add_f32 v13, v13, v131
v_max3_f32 v6, v147, v148, v149
ds_read_b128 v[220:223], v9 offset:14336
s_waitcnt lgkmcnt(4)
v_mfma_f32_32x32x16_bf16 v[96:111], v[236:239], v[180:183], v[96:111]
buffer_load_dwordx4 v10, s[20:23], s67 offen offset:2048 lds
v_add_f32 v12, v12, v132
v_add_f32 v13, v13, v133
v_max3_f32 v14, v14, v150, v151
v_max3_f32 v6, v6, v152, v153
ds_read_b128 v[224:227], v9 offset:9216
s_waitcnt lgkmcnt(4)
v_mfma_f32_32x32x16_bf16 v[48:63], v[208:211], v[184:187], v[48:63]
v_add_f32 v12, v12, v134
v_add_f32 v13, v13, v135
v_add_f32 v12, v12, v136
v_max3_f32 v14, v14, v154, v155
ds_read_b128 v[228:231], v9 offset:11264
s_waitcnt lgkmcnt(4)
v_mfma_f32_32x32x16_bf16 v[64:79], v[212:215], v[184:187], v[64:79]
v_add_f32 v13, v13, v137
v_add_f32 v12, v12, v138
v_max3_f32 v6, v6, v156, v157
v_max3_f32 v14, v14, v158, v159
ds_read_b128 v[232:235], v9 offset:13312
s_waitcnt lgkmcnt(4)
v_mfma_f32_32x32x16_bf16 v[80:95], v[216:219], v[184:187], v[80:95]
buffer_load_dwordx4 v10, s[20:23], s67 offen offset:3072 lds
s_add_u32 s67, s67, 32768
v_add_f32 v13, v13, v139
v_add_f32 v12, v12, v140
v_max3_f32 v6, v6, v160, v161
ds_read_b128 v[236:239], v9 offset:15360
s_waitcnt lgkmcnt(4)
v_mfma_f32_32x32x16_bf16 v[96:111], v[220:223], v[184:187], v[96:111]
v_add_f32 v13, v13, v141
v_add_f32 v12, v12, v142
v_add_f32 v13, v13, v143
v_max3_f32 v14, v14, v162, v163
v_max3_f32 v6, v6, v164, v165
s_waitcnt vmcnt(5)
s_barrier
ds_read_b128 v[208:211], v8 offset:0
s_waitcnt lgkmcnt(4)
v_mfma_f32_32x32x16_bf16 v[48:63], v[224:227], v[188:191], v[48:63]
v_max3_f32 v14, v14, v166, v167
ds_read_b128 v[212:215], v8 offset:1024
s_waitcnt lgkmcnt(4)
v_mfma_f32_32x32x16_bf16 v[64:79], v[228:231], v[188:191], v[64:79]
v_max3_f32 v6, v6, v168, v169
v_max3_f32 v14, v14, v170, v171
ds_read_b128 v[216:219], v8 offset:2048
s_waitcnt lgkmcnt(4)
v_mfma_f32_32x32x16_bf16 v[80:95], v[232:235], v[188:191], v[80:95]
v_max3_f32 v6, v6, v172, v173
ds_read_b128 v[220:223], v8 offset:3072
s_waitcnt lgkmcnt(4)
v_mfma_f32_32x32x16_bf16 v[96:111], v[236:239], v[188:191], v[96:111]
v_max3_f32 v14, v14, v174, v175
v_max_f32 v14, v14, v6
v_cmp_lt_f32 vcc, 0x41000000, v14
s_sub_u32 s68, s68, 1
s_nop 0
s_cbranch_vccnz .attn_R49
.attn_Rr50:
.attn_P44:
s_cmp_eq_u32 s68, 0
s_cbranch_scc1 .attn_T46
s_cmp_gt_u32 s68, 1
s_cselect_b32 s18, s18, 0
ds_read_b128 v[224:227], v8 offset:4096
s_waitcnt lgkmcnt(4)
v_mfma_f32_32x32x16_bf16 v[112:127], v[208:211], v[16:19], v[192:207]
v_exp_f32 v144, v144
v_exp_f32 v145, v145
v_exp_f32 v146, v146
ds_read_b128 v[228:231], v8 offset:5120
s_waitcnt lgkmcnt(4)
v_mfma_f32_32x32x16_bf16 v[112:127], v[212:215], v[20:23], v[112:127]
s_add_u32 m0, s63, 32768
s_nop 0
buffer_load_dwordx4 v10, s[16:19], s66 offen offset:0 lds
v_exp_f32 v147, v147
v_exp_f32 v148, v148
v_exp_f32 v149, v149
ds_read_b128 v[232:235], v8 offset:6144
s_waitcnt lgkmcnt(4)
v_mfma_f32_32x32x16_bf16 v[112:127], v[216:219], v[24:27], v[112:127]
v_exp_f32 v150, v150
v_exp_f32 v151, v151
v_exp_f32 v152, v152
ds_read_b128 v[236:239], v8 offset:7168
s_waitcnt lgkmcnt(4)
v_mfma_f32_32x32x16_bf16 v[112:127], v[220:223], v[28:31], v[112:127]
v_exp_f32 v153, v153
v_cvt_pk_bf16_f32 v176, v144, v145
v_cvt_pk_bf16_f32 v177, v146, v147
v_cvt_pk_bf16_f32 v178, v148, v149
ds_read_b128 v[208:211], v8 offset:8192
s_waitcnt lgkmcnt(4)
v_mfma_f32_32x32x16_bf16 v[112:127], v[224:227], v[32:35], v[112:127]
buffer_load_dwordx4 v10, s[16:19], s66 offen offset:1024 lds
v_cvt_pk_bf16_f32 v179, v150, v151
v_exp_f32 v154, v154
v_exp_f32 v155, v155
ds_read_b128 v[212:215], v8 offset:9216
s_waitcnt lgkmcnt(4)
v_mfma_f32_32x32x16_bf16 v[112:127], v[228:231], v[36:39], v[112:127]
v_exp_f32 v156, v156
v_exp_f32 v157, v157
v_exp_f32 v158, v158
ds_read_b128 v[216:219], v8 offset:10240
s_waitcnt lgkmcnt(4)
v_mfma_f32_32x32x16_bf16 v[112:127], v[232:235], v[40:43], v[112:127]
v_exp_f32 v159, v159
v_add_f32 v12, v12, v144
v_add_f32 v13, v13, v145
ds_read_b128 v[220:223], v8 offset:11264
s_waitcnt lgkmcnt(4)
v_mfma_f32_32x32x16_bf16 v[112:127], v[236:239], v[44:47], v[112:127]
buffer_load_dwordx4 v10, s[16:19], s66 offen offset:2048 lds
v_cvt_pk_bf16_f32 v180, v152, v153
v_cvt_pk_bf16_f32 v181, v154, v155
v_cvt_pk_bf16_f32 v182, v156, v157
v_cvt_pk_bf16_f32 v183, v158, v159
ds_read_b128 v[224:227], v8 offset:12288
s_waitcnt lgkmcnt(4)
v_mfma_f32_32x32x16_bf16 v[128:143], v[208:211], v[16:19], v[192:207]
v_add_f32 v12, v12, v146
v_add_f32 v13, v13, v147
v_add_f32 v12, v12, v148
ds_read_b128 v[228:231], v8 offset:13312
s_waitcnt lgkmcnt(4)
v_mfma_f32_32x32x16_bf16 v[128:143], v[212:215], v[20:23], v[128:143]
v_add_f32 v13, v13, v149
v_add_f32 v12, v12, v150
v_add_f32 v13, v13, v151
ds_read_b128 v[232:235], v8 offset:14336
s_waitcnt lgkmcnt(4)
v_mfma_f32_32x32x16_bf16 v[128:143], v[216:219], v[24:27], v[128:143]
buffer_load_dwordx4 v10, s[16:19], s66 offen offset:3072 lds
s_add_u32 s66, s66, 32768
v_exp_f32 v160, v160
v_exp_f32 v161, v161
v_exp_f32 v162, v162
ds_read_b128 v[236:239], v8 offset:15360
s_waitcnt lgkmcnt(4)
v_mfma_f32_32x32x16_bf16 v[128:143], v[220:223], v[28:31], v[128:143]
v_exp_f32 v163, v163
v_exp_f32 v164, v164
v_exp_f32 v165, v165
v_exp_f32 v166, v166
buffer_load_dword v241, v240, s[28:31], 0 offen
v_add_u32 v240, s79, v240
s_waitcnt vmcnt(5)
s_barrier
ds_read_b128 v[208:211], v9 offset:32768
s_waitcnt lgkmcnt(4)
v_mfma_f32_32x32x16_bf16 v[128:143], v[224:227], v[32:35], v[128:143]
v_exp_f32 v167, v167
v_add_f32 v12, v12, v152
v_add_f32 v13, v13, v153
ds_read_b128 v[212:215], v9 offset:34816
s_waitcnt lgkmcnt(4)
v_mfma_f32_32x32x16_bf16 v[128:143], v[228:231], v[36:39], v[128:143]
v_cvt_pk_bf16_f32 v184, v160, v161
v_cvt_pk_bf16_f32 v185, v162, v163
v_cvt_pk_bf16_f32 v186, v164, v165
ds_read_b128 v[216:219], v9 offset:36864
s_waitcnt lgkmcnt(4)
v_mfma_f32_32x32x16_bf16 v[128:143], v[232:235], v[40:43], v[128:143]
v_cvt_pk_bf16_f32 v187, v166, v167
v_add_f32 v12, v12, v154
v_add_f32 v13, v13, v155
ds_read_b128 v[220:223], v9 offset:38912
s_waitcnt lgkmcnt(4)
v_mfma_f32_32x32x16_bf16 v[128:143], v[236:239], v[44:47], v[128:143]
v_add_f32 v12, v12, v156
v_add_f32 v13, v13, v157
v_add_f32 v12, v12, v158
v_add_f32 v13, v13, v159
s_cmp_lg_u32 s68, 1
s_cbranch_scc1 .attn_L51
s_nop 7
s_nop 4
v_mov_b32 v7, 0xf149f2ca
v_cmp_gt_i32 s[70:71], 0, v11
v_cmp_gt_i32 s[72:73], 1, v11
v_cmp_gt_i32 s[74:75], 2, v11
v_cmp_gt_i32 s[76:77], 3, v11
v_cndmask_b32 v112, v112, v7, s[70:71]
v_cndmask_b32 v113, v113, v7, s[72:73]
v_cndmask_b32 v114, v114, v7, s[74:75]
v_cndmask_b32 v115, v115, v7, s[76:77]
v_cmp_gt_i32 s[70:71], 8, v11
v_cmp_gt_i32 s[72:73], 9, v11
v_cmp_gt_i32 s[74:75], 10, v11
v_cmp_gt_i32 s[76:77], 11, v11
v_cndmask_b32 v116, v116, v7, s[70:71]
v_cndmask_b32 v117, v117, v7, s[72:73]
v_cndmask_b32 v118, v118, v7, s[74:75]
v_cndmask_b32 v119, v119, v7, s[76:77]
v_cmp_gt_i32 s[70:71], 16, v11
v_cmp_gt_i32 s[72:73], 17, v11
v_cmp_gt_i32 s[74:75], 18, v11
v_cmp_gt_i32 s[76:77], 19, v11
v_cndmask_b32 v120, v120, v7, s[70:71]
v_cndmask_b32 v121, v121, v7, s[72:73]
v_cndmask_b32 v122, v122, v7, s[74:75]
v_cndmask_b32 v123, v123, v7, s[76:77]
v_cmp_gt_i32 s[70:71], 24, v11
v_cmp_gt_i32 s[72:73], 25, v11
v_cmp_gt_i32 s[74:75], 26, v11
v_cmp_gt_i32 s[76:77], 27, v11
v_cndmask_b32 v124, v124, v7, s[70:71]
v_cndmask_b32 v125, v125, v7, s[72:73]
v_cndmask_b32 v126, v126, v7, s[74:75]
v_cndmask_b32 v127, v127, v7, s[76:77]
v_cmp_gt_i32 s[70:71], 32, v11
v_cmp_gt_i32 s[72:73], 33, v11
v_cmp_gt_i32 s[74:75], 34, v11
v_cmp_gt_i32 s[76:77], 35, v11
v_cndmask_b32 v128, v128, v7, s[70:71]
v_cndmask_b32 v129, v129, v7, s[72:73]
v_cndmask_b32 v130, v130, v7, s[74:75]
v_cndmask_b32 v131, v131, v7, s[76:77]
v_cmp_gt_i32 s[70:71], 40, v11
v_cmp_gt_i32 s[72:73], 41, v11
v_cmp_gt_i32 s[74:75], 42, v11
v_cmp_gt_i32 s[76:77], 43, v11
v_cndmask_b32 v132, v132, v7, s[70:71]
v_cndmask_b32 v133, v133, v7, s[72:73]
v_cndmask_b32 v134, v134, v7, s[74:75]
v_cndmask_b32 v135, v135, v7, s[76:77]
v_cmp_gt_i32 s[70:71], 48, v11
v_cmp_gt_i32 s[72:73], 49, v11
v_cmp_gt_i32 s[74:75], 50, v11
v_cmp_gt_i32 s[76:77], 51, v11
v_cndmask_b32 v136, v136, v7, s[70:71]
v_cndmask_b32 v137, v137, v7, s[72:73]
v_cndmask_b32 v138, v138, v7, s[74:75]
v_cndmask_b32 v139, v139, v7, s[76:77]
v_cmp_gt_i32 s[70:71], 56, v11
v_cmp_gt_i32 s[72:73], 57, v11
v_cmp_gt_i32 s[74:75], 58, v11
v_cmp_gt_i32 s[76:77], 59, v11
v_cndmask_b32 v140, v140, v7, s[70:71]
v_cndmask_b32 v141, v141, v7, s[72:73]
v_cndmask_b32 v142, v142, v7, s[74:75]
v_cndmask_b32 v143, v143, v7, s[76:77]
.attn_L51:
ds_read_b128 v[224:227], v9 offset:33792
s_waitcnt lgkmcnt(4)
v_mfma_f32_32x32x16_bf16 v[48:63], v[208:211], v[176:179], v[48:63]
v_exp_f32 v168, v168
v_exp_f32 v169, v169
ds_read_b128 v[228:231], v9 offset:35840
s_waitcnt lgkmcnt(4)
v_mfma_f32_32x32x16_bf16 v[64:79], v[212:215], v[176:179], v[64:79]
s_add_u32 m0, s65, 0
s_nop 0
buffer_load_dwordx4 v10, s[20:23], s67 offen offset:0 lds
v_exp_f32 v170, v170
v_exp_f32 v171, v171
ds_read_b128 v[232:235], v9 offset:37888
s_waitcnt lgkmcnt(4)
v_mfma_f32_32x32x16_bf16 v[80:95], v[216:219], v[176:179], v[80:95]
v_exp_f32 v172, v172
v_exp_f32 v173, v173
v_exp_f32 v174, v174
ds_read_b128 v[236:239], v9 offset:39936
s_waitcnt lgkmcnt(4)
v_mfma_f32_32x32x16_bf16 v[96:111], v[220:223], v[176:179], v[96:111]
v_exp_f32 v175, v175
v_add_f32 v12, v12, v160
ds_read_b128 v[208:211], v9 offset:40960
s_waitcnt lgkmcnt(4)
v_mfma_f32_32x32x16_bf16 v[48:63], v[224:227], v[180:183], v[48:63]
buffer_load_dwordx4 v10, s[20:23], s67 offen offset:1024 lds
v_add_f32 v13, v13, v161
v_cvt_pk_bf16_f32 v188, v168, v169
ds_read_b128 v[212:215], v9 offset:43008
s_waitcnt lgkmcnt(4)
v_mfma_f32_32x32x16_bf16 v[64:79], v[228:231], v[180:183], v[64:79]
v_cvt_pk_bf16_f32 v189, v170, v171
v_cvt_pk_bf16_f32 v190, v172, v173
v_cvt_pk_bf16_f32 v191, v174, v175
v_max3_f32 v14, v112, v113, v114
ds_read_b128 v[216:219], v9 offset:45056
s_waitcnt lgkmcnt(4)
v_mfma_f32_32x32x16_bf16 v[80:95], v[232:235], v[180:183], v[80:95]
v_add_f32 v12, v12, v162
v_add_f32 v13, v13, v163
v_max3_f32 v6, v115, v116, v117
ds_read_b128 v[220:223], v9 offset:47104
s_waitcnt lgkmcnt(4)
v_mfma_f32_32x32x16_bf16 v[96:111], v[236:239], v[180:183], v[96:111]
buffer_load_dwordx4 v10, s[20:23], s67 offen offset:2048 lds
v_add_f32 v12, v12, v164
v_add_f32 v13, v13, v165
v_max3_f32 v14, v14, v118, v119
v_max3_f32 v6, v6, v120, v121
ds_read_b128 v[224:227], v9 offset:41984
s_waitcnt lgkmcnt(4)
v_mfma_f32_32x32x16_bf16 v[48:63], v[208:211], v[184:187], v[48:63]
v_add_f32 v12, v12, v166
v_add_f32 v13, v13, v167
v_add_f32 v12, v12, v168
v_max3_f32 v14, v14, v122, v123
ds_read_b128 v[228:231], v9 offset:44032
s_waitcnt lgkmcnt(4)
v_mfma_f32_32x32x16_bf16 v[64:79], v[212:215], v[184:187], v[64:79]
v_add_f32 v13, v13, v169
v_add_f32 v12, v12, v170
v_max3_f32 v6, v6, v124, v125
v_max3_f32 v14, v14, v126, v127
ds_read_b128 v[232:235], v9 offset:46080
s_waitcnt lgkmcnt(4)
v_mfma_f32_32x32x16_bf16 v[80:95], v[216:219], v[184:187], v[80:95]
buffer_load_dwordx4 v10, s[20:23], s67 offen offset:3072 lds
s_add_u32 s67, s67, 32768
v_add_f32 v13, v13, v171
v_add_f32 v12, v12, v172
v_max3_f32 v6, v6, v128, v129
ds_read_b128 v[236:239], v9 offset:48128
s_waitcnt lgkmcnt(4)
v_mfma_f32_32x32x16_bf16 v[96:111], v[220:223], v[184:187], v[96:111]
v_add_f32 v13, v13, v173
v_add_f32 v12, v12, v174
v_add_f32 v13, v13, v175
v_max3_f32 v14, v14, v130, v131
v_max3_f32 v6, v6, v132, v133
s_waitcnt vmcnt(5)
s_barrier
ds_read_b128 v[208:211], v8 offset:32768
s_waitcnt lgkmcnt(4)
v_mfma_f32_32x32x16_bf16 v[48:63], v[224:227], v[188:191], v[48:63]
v_max3_f32 v14, v14, v134, v135
ds_read_b128 v[212:215], v8 offset:33792
s_waitcnt lgkmcnt(4)
v_mfma_f32_32x32x16_bf16 v[64:79], v[228:231], v[188:191], v[64:79]
v_max3_f32 v6, v6, v136, v137
v_max3_f32 v14, v14, v138, v139
ds_read_b128 v[216:219], v8 offset:34816
s_waitcnt lgkmcnt(4)
v_mfma_f32_32x32x16_bf16 v[80:95], v[232:235], v[188:191], v[80:95]
v_max3_f32 v6, v6, v140, v141
ds_read_b128 v[220:223], v8 offset:35840
s_waitcnt lgkmcnt(4)
v_mfma_f32_32x32x16_bf16 v[96:111], v[236:239], v[188:191], v[96:111]
v_max3_f32 v14, v14, v142, v143
v_max_f32 v14, v14, v6
v_cmp_lt_f32 vcc, 0x41000000, v14
s_sub_u32 s68, s68, 1
s_nop 0
s_cbranch_vccnz .attn_R52
.attn_Rr53:
s_branch .attn_P43
.attn_R49:
v_mov_b32 v6, v14
s_nop 1
v_permlane32_swap_b32 v6, v14
s_nop 1
v_max_f32 v14, v14, v6
v_max_f32 v14, 0, v14
s_nop 7
v_exp_f32 v6, -v14
v_sub_f32 v144, v144, v14
v_sub_f32 v145, v145, v14
v_sub_f32 v146, v146, v14
v_sub_f32 v147, v147, v14
v_sub_f32 v148, v148, v14
v_sub_f32 v149, v149, v14
v_sub_f32 v150, v150, v14
v_sub_f32 v151, v151, v14
v_sub_f32 v152, v152, v14
v_sub_f32 v153, v153, v14
v_sub_f32 v154, v154, v14
v_sub_f32 v155, v155, v14
v_sub_f32 v156, v156, v14
v_sub_f32 v157, v157, v14
v_sub_f32 v158, v158, v14
v_sub_f32 v159, v159, v14
v_sub_f32 v160, v160, v14
v_sub_f32 v161, v161, v14
v_sub_f32 v162, v162, v14
v_sub_f32 v163, v163, v14
v_sub_f32 v164, v164, v14
v_sub_f32 v165, v165, v14
v_sub_f32 v166, v166, v14
v_sub_f32 v167, v167, v14
v_sub_f32 v168, v168, v14
v_sub_f32 v169, v169, v14
v_sub_f32 v170, v170, v14
v_sub_f32 v171, v171, v14
v_sub_f32 v172, v172, v14
v_sub_f32 v173, v173, v14
v_sub_f32 v174, v174, v14
v_sub_f32 v175, v175, v14
v_sub_f32 v192, v192, v14
v_sub_f32 v193, v193, v14
v_sub_f32 v194, v194, v14
v_sub_f32 v195, v195, v14
v_sub_f32 v196, v196, v14
v_sub_f32 v197, v197, v14
v_sub_f32 v198, v198, v14
v_sub_f32 v199, v199, v14
v_sub_f32 v200, v200, v14
v_sub_f32 v201, v201, v14
v_sub_f32 v202, v202, v14
v_sub_f32 v203, v203, v14
v_sub_f32 v204, v204, v14
v_sub_f32 v205, v205, v14
v_sub_f32 v206, v206, v14
v_sub_f32 v207, v207, v14
v_mul_f32 v12, v6, v12
v_mul_f32 v13, v6, v13
v_mul_f32 v48, v6, v48
v_mul_f32 v49, v6, v49
v_mul_f32 v50, v6, v50
v_mul_f32 v51, v6, v51
v_mul_f32 v52, v6, v52
v_mul_f32 v53, v6, v53
v_mul_f32 v54, v6, v54
v_mul_f32 v55, v6, v55
v_mul_f32 v56, v6, v56
v_mul_f32 v57, v6, v57
v_mul_f32 v58, v6, v58
v_mul_f32 v59, v6, v59
v_mul_f32 v60, v6, v60
v_mul_f32 v61, v6, v61
v_mul_f32 v62, v6, v62
v_mul_f32 v63, v6, v63
v_mul_f32 v64, v6, v64
v_mul_f32 v65, v6, v65
v_mul_f32 v66, v6, v66
v_mul_f32 v67, v6, v67
v_mul_f32 v68, v6, v68
v_mul_f32 v69, v6, v69
v_mul_f32 v70, v6, v70
v_mul_f32 v71, v6, v71
v_mul_f32 v72, v6, v72
v_mul_f32 v73, v6, v73
v_mul_f32 v74, v6, v74
v_mul_f32 v75, v6, v75
v_mul_f32 v76, v6, v76
v_mul_f32 v77, v6, v77
v_mul_f32 v78, v6, v78
v_mul_f32 v79, v6, v79
v_mul_f32 v80, v6, v80
v_mul_f32 v81, v6, v81
v_mul_f32 v82, v6, v82
v_mul_f32 v83, v6, v83
v_mul_f32 v84, v6, v84
v_mul_f32 v85, v6, v85
v_mul_f32 v86, v6, v86
v_mul_f32 v87, v6, v87
v_mul_f32 v88, v6, v88
v_mul_f32 v89, v6, v89
v_mul_f32 v90, v6, v90
v_mul_f32 v91, v6, v91
v_mul_f32 v92, v6, v92
v_mul_f32 v93, v6, v93
v_mul_f32 v94, v6, v94
v_mul_f32 v95, v6, v95
v_mul_f32 v96, v6, v96
v_mul_f32 v97, v6, v97
v_mul_f32 v98, v6, v98
v_mul_f32 v99, v6, v99
v_mul_f32 v100, v6, v100
v_mul_f32 v101, v6, v101
v_mul_f32 v102, v6, v102
v_mul_f32 v103, v6, v103
v_mul_f32 v104, v6, v104
v_mul_f32 v105, v6, v105
v_mul_f32 v106, v6, v106
v_mul_f32 v107, v6, v107
v_mul_f32 v108, v6, v108
v_mul_f32 v109, v6, v109
v_mul_f32 v110, v6, v110
v_mul_f32 v111, v6, v111
s_nop 1
s_branch .attn_Rr50
.attn_R52:
v_mov_b32 v6, v14
s_nop 1
v_permlane32_swap_b32 v6, v14
s_nop 1
v_max_f32 v14, v14, v6
v_max_f32 v14, 0, v14
s_nop 7
v_exp_f32 v6, -v14
v_sub_f32 v112, v112, v14
v_sub_f32 v113, v113, v14
v_sub_f32 v114, v114, v14
v_sub_f32 v115, v115, v14
v_sub_f32 v116, v116, v14
v_sub_f32 v117, v117, v14
v_sub_f32 v118, v118, v14
v_sub_f32 v119, v119, v14
v_sub_f32 v120, v120, v14
v_sub_f32 v121, v121, v14
v_sub_f32 v122, v122, v14
v_sub_f32 v123, v123, v14
v_sub_f32 v124, v124, v14
v_sub_f32 v125, v125, v14
v_sub_f32 v126, v126, v14
v_sub_f32 v127, v127, v14
v_sub_f32 v128, v128, v14
v_sub_f32 v129, v129, v14
v_sub_f32 v130, v130, v14
v_sub_f32 v131, v131, v14
v_sub_f32 v132, v132, v14
v_sub_f32 v133, v133, v14
v_sub_f32 v134, v134, v14
v_sub_f32 v135, v135, v14
v_sub_f32 v136, v136, v14
v_sub_f32 v137, v137, v14
v_sub_f32 v138, v138, v14
v_sub_f32 v139, v139, v14
v_sub_f32 v140, v140, v14
v_sub_f32 v141, v141, v14
v_sub_f32 v142, v142, v14
v_sub_f32 v143, v143, v14
v_sub_f32 v192, v192, v14
v_sub_f32 v193, v193, v14
v_sub_f32 v194, v194, v14
v_sub_f32 v195, v195, v14
v_sub_f32 v196, v196, v14
v_sub_f32 v197, v197, v14
v_sub_f32 v198, v198, v14
v_sub_f32 v199, v199, v14
v_sub_f32 v200, v200, v14
v_sub_f32 v201, v201, v14
v_sub_f32 v202, v202, v14
v_sub_f32 v203, v203, v14
v_sub_f32 v204, v204, v14
v_sub_f32 v205, v205, v14
v_sub_f32 v206, v206, v14
v_sub_f32 v207, v207, v14
v_mul_f32 v12, v6, v12
v_mul_f32 v13, v6, v13
v_mul_f32 v48, v6, v48
v_mul_f32 v49, v6, v49
v_mul_f32 v50, v6, v50
v_mul_f32 v51, v6, v51
v_mul_f32 v52, v6, v52
v_mul_f32 v53, v6, v53
v_mul_f32 v54, v6, v54
v_mul_f32 v55, v6, v55
v_mul_f32 v56, v6, v56
v_mul_f32 v57, v6, v57
v_mul_f32 v58, v6, v58
v_mul_f32 v59, v6, v59
v_mul_f32 v60, v6, v60
v_mul_f32 v61, v6, v61
v_mul_f32 v62, v6, v62
v_mul_f32 v63, v6, v63
v_mul_f32 v64, v6, v64
v_mul_f32 v65, v6, v65
v_mul_f32 v66, v6, v66
v_mul_f32 v67, v6, v67
v_mul_f32 v68, v6, v68
v_mul_f32 v69, v6, v69
v_mul_f32 v70, v6, v70
v_mul_f32 v71, v6, v71
v_mul_f32 v72, v6, v72
v_mul_f32 v73, v6, v73
v_mul_f32 v74, v6, v74
v_mul_f32 v75, v6, v75
v_mul_f32 v76, v6, v76
v_mul_f32 v77, v6, v77
v_mul_f32 v78, v6, v78
v_mul_f32 v79, v6, v79
v_mul_f32 v80, v6, v80
v_mul_f32 v81, v6, v81
v_mul_f32 v82, v6, v82
v_mul_f32 v83, v6, v83
v_mul_f32 v84, v6, v84
v_mul_f32 v85, v6, v85
v_mul_f32 v86, v6, v86
v_mul_f32 v87, v6, v87
v_mul_f32 v88, v6, v88
v_mul_f32 v89, v6, v89
v_mul_f32 v90, v6, v90
v_mul_f32 v91, v6, v91
v_mul_f32 v92, v6, v92
v_mul_f32 v93, v6, v93
v_mul_f32 v94, v6, v94
v_mul_f32 v95, v6, v95
v_mul_f32 v96, v6, v96
v_mul_f32 v97, v6, v97
v_mul_f32 v98, v6, v98
v_mul_f32 v99, v6, v99
v_mul_f32 v100, v6, v100
v_mul_f32 v101, v6, v101
v_mul_f32 v102, v6, v102
v_mul_f32 v103, v6, v103
v_mul_f32 v104, v6, v104
v_mul_f32 v105, v6, v105
v_mul_f32 v106, v6, v106
v_mul_f32 v107, v6, v107
v_mul_f32 v108, v6, v108
v_mul_f32 v109, v6, v109
v_mul_f32 v110, v6, v110
v_mul_f32 v111, v6, v111
s_nop 1
s_branch .attn_Rr53
.attn_T45:
s_waitcnt vmcnt(0)
s_barrier
ds_read_b128 v[208:211], v9 offset:0
ds_read_b128 v[212:215], v9 offset:2048
ds_read_b128 v[216:219], v9 offset:4096
ds_read_b128 v[220:223], v9 offset:6144
s_cmp_lg_u32 s69, 0
s_cbranch_scc1 .attn_L54
s_mov_b32 s66, s64
s_mov_b32 s67, s64
s_mov_b32 s18, 0x1000000
s_add_u32 m0, s63, 0
s_nop 0
buffer_load_dwordx4 v10, s[16:19], s66 offen offset:0 lds
buffer_load_dwordx4 v10, s[16:19], s66 offen offset:1024 lds
buffer_load_dwordx4 v10, s[16:19], s66 offen offset:2048 lds
buffer_load_dwordx4 v10, s[16:19], s66 offen offset:3072 lds
s_add_u32 s66, s66, 32768
.attn_L54:
v_exp_f32 v112, v112
v_exp_f32 v113, v113
v_exp_f32 v114, v114
v_exp_f32 v115, v115
v_exp_f32 v116, v116
v_exp_f32 v117, v117
v_exp_f32 v118, v118
v_exp_f32 v119, v119
s_nop 0
v_cvt_pk_bf16_f32 v176, v112, v113
v_cvt_pk_bf16_f32 v177, v114, v115
v_cvt_pk_bf16_f32 v178, v116, v117
v_cvt_pk_bf16_f32 v179, v118, v119
s_nop 1
ds_read_b128 v[224:227], v9 offset:1024
s_waitcnt lgkmcnt(4)
v_mfma_f32_32x32x16_bf16 v[48:63], v[208:211], v[176:179], v[48:63]
v_exp_f32 v120, v120
v_exp_f32 v121, v121
v_exp_f32 v122, v122
v_exp_f32 v123, v123
v_exp_f32 v124, v124
ds_read_b128 v[228:231], v9 offset:3072
s_waitcnt lgkmcnt(4)
v_mfma_f32_32x32x16_bf16 v[64:79], v[212:215], v[176:179], v[64:79]
v_exp_f32 v125, v125
v_exp_f32 v126, v126
v_exp_f32 v127, v127
v_add_f32 v12, v12, v112
v_add_f32 v13, v13, v113
ds_read_b128 v[232:235], v9 offset:5120
s_waitcnt lgkmcnt(4)
v_mfma_f32_32x32x16_bf16 v[80:95], v[216:219], v[176:179], v[80:95]
v_cvt_pk_bf16_f32 v180, v120, v121
v_cvt_pk_bf16_f32 v181, v122, v123
v_cvt_pk_bf16_f32 v182, v124, v125
v_cvt_pk_bf16_f32 v183, v126, v127
v_add_f32 v12, v12, v114
ds_read_b128 v[236:239], v9 offset:7168
s_waitcnt lgkmcnt(4)
v_mfma_f32_32x32x16_bf16 v[96:111], v[220:223], v[176:179], v[96:111]
v_add_f32 v13, v13, v115
v_add_f32 v12, v12, v116
v_add_f32 v13, v13, v117
v_add_f32 v12, v12, v118
v_add_f32 v13, v13, v119
ds_read_b128 v[208:211], v9 offset:8192
s_waitcnt lgkmcnt(4)
v_mfma_f32_32x32x16_bf16 v[48:63], v[224:227], v[180:183], v[48:63]
v_exp_f32 v128, v128
v_exp_f32 v129, v129
v_exp_f32 v130, v130
v_exp_f32 v131, v131
v_exp_f32 v132, v132
ds_read_b128 v[212:215], v9 offset:10240
s_waitcnt lgkmcnt(4)
v_mfma_f32_32x32x16_bf16 v[64:79], v[228:231], v[180:183], v[64:79]
v_exp_f32 v133, v133
v_exp_f32 v134, v134
v_exp_f32 v135, v135
v_add_f32 v12, v12, v120
v_add_f32 v13, v13, v121
ds_read_b128 v[216:219], v9 offset:12288
s_waitcnt lgkmcnt(4)
v_mfma_f32_32x32x16_bf16 v[80:95], v[232:235], v[180:183], v[80:95]
v_cvt_pk_bf16_f32 v184, v128, v129
v_cvt_pk_bf16_f32 v185, v130, v131
v_cvt_pk_bf16_f32 v186, v132, v133
v_cvt_pk_bf16_f32 v187, v134, v135
v_add_f32 v12, v12, v122
ds_read_b128 v[220:223], v9 offset:14336
s_waitcnt lgkmcnt(4)
v_mfma_f32_32x32x16_bf16 v[96:111], v[236:239], v[180:183], v[96:111]
v_add_f32 v13, v13, v123
v_add_f32 v12, v12, v124
v_add_f32 v13, v13, v125
v_add_f32 v12, v12, v126
v_add_f32 v13, v13, v127
ds_read_b128 v[224:227], v9 offset:9216
s_waitcnt lgkmcnt(4)
v_mfma_f32_32x32x16_bf16 v[48:63], v[208:211], v[184:187], v[48:63]
v_exp_f32 v136, v136
v_exp_f32 v137, v137
v_exp_f32 v138, v138
v_exp_f32 v139, v139
v_exp_f32 v140, v140
ds_read_b128 v[228:231], v9 offset:11264
s_waitcnt lgkmcnt(4)
v_mfma_f32_32x32x16_bf16 v[64:79], v[212:215], v[184:187], v[64:79]
v_exp_f32 v141, v141
v_exp_f32 v142, v142
v_exp_f32 v143, v143
v_add_f32 v12, v12, v128
v_add_f32 v13, v13, v129
ds_read_b128 v[232:235], v9 offset:13312
s_waitcnt lgkmcnt(4)
v_mfma_f32_32x32x16_bf16 v[80:95], v[216:219], v[184:187], v[80:95]
v_cvt_pk_bf16_f32 v188, v136, v137
v_cvt_pk_bf16_f32 v189, v138, v139
v_cvt_pk_bf16_f32 v190, v140, v141
v_cvt_pk_bf16_f32 v191, v142, v143
v_add_f32 v12, v12, v130
ds_read_b128 v[236:239], v9 offset:15360
s_waitcnt lgkmcnt(4)
v_mfma_f32_32x32x16_bf16 v[96:111], v[220:223], v[184:187], v[96:111]
v_add_f32 v13, v13, v131
v_add_f32 v12, v12, v132
v_add_f32 v13, v13, v133
v_add_f32 v12, v12, v134
v_add_f32 v13, v13, v135
s_waitcnt lgkmcnt(3)
v_mfma_f32_32x32x16_bf16 v[48:63], v[224:227], v[188:191], v[48:63]
v_add_f32 v12, v12, v136
v_add_f32 v13, v13, v137
s_waitcnt lgkmcnt(2)
v_mfma_f32_32x32x16_bf16 v[64:79], v[228:231], v[188:191], v[64:79]
v_add_f32 v12, v12, v138
v_add_f32 v13, v13, v139
s_waitcnt lgkmcnt(1)
v_mfma_f32_32x32x16_bf16 v[80:95], v[232:235], v[188:191], v[80:95]
v_add_f32 v12, v12, v140
v_add_f32 v13, v13, v141
s_waitcnt lgkmcnt(0)
v_mfma_f32_32x32x16_bf16 v[96:111], v[236:239], v[188:191], v[96:111]
v_add_f32 v12, v12, v142
v_add_f32 v13, v13, v143
s_mov_b32 s4, 0x8000
s_branch .attn_F47
.attn_T46:
s_waitcnt vmcnt(0)
s_barrier
ds_read_b128 v[208:211], v9 offset:32768
ds_read_b128 v[212:215], v9 offset:34816
ds_read_b128 v[216:219], v9 offset:36864
ds_read_b128 v[220:223], v9 offset:38912
s_cmp_lg_u32 s69, 0
s_cbranch_scc1 .attn_L55
s_mov_b32 s66, s64
s_mov_b32 s67, s64
s_mov_b32 s18, 0x1000000
s_add_u32 m0, s63, 0
s_nop 0
buffer_load_dwordx4 v10, s[16:19], s66 offen offset:0 lds
buffer_load_dwordx4 v10, s[16:19], s66 offen offset:1024 lds
buffer_load_dwordx4 v10, s[16:19], s66 offen offset:2048 lds
buffer_load_dwordx4 v10, s[16:19], s66 offen offset:3072 lds
s_add_u32 s66, s66, 32768
.attn_L55:
v_exp_f32 v144, v144
v_exp_f32 v145, v145
v_exp_f32 v146, v146
v_exp_f32 v147, v147
v_exp_f32 v148, v148
v_exp_f32 v149, v149
v_exp_f32 v150, v150
v_exp_f32 v151, v151
s_nop 0
v_cvt_pk_bf16_f32 v176, v144, v145
v_cvt_pk_bf16_f32 v177, v146, v147
v_cvt_pk_bf16_f32 v178, v148, v149
v_cvt_pk_bf16_f32 v179, v150, v151
s_nop 1
ds_read_b128 v[224:227], v9 offset:33792
s_waitcnt lgkmcnt(4)
v_mfma_f32_32x32x16_bf16 v[48:63], v[208:211], v[176:179], v[48:63]
v_exp_f32 v152, v152
v_exp_f32 v153, v153
v_exp_f32 v154, v154
v_exp_f32 v155, v155
v_exp_f32 v156, v156
ds_read_b128 v[228:231], v9 offset:35840
s_waitcnt lgkmcnt(4)
v_mfma_f32_32x32x16_bf16 v[64:79], v[212:215], v[176:179], v[64:79]
v_exp_f32 v157, v157
v_exp_f32 v158, v158
v_exp_f32 v159, v159
v_add_f32 v12, v12, v144
v_add_f32 v13, v13, v145
ds_read_b128 v[232:235], v9 offset:37888
s_waitcnt lgkmcnt(4)
v_mfma_f32_32x32x16_bf16 v[80:95], v[216:219], v[176:179], v[80:95]
v_cvt_pk_bf16_f32 v180, v152, v153
v_cvt_pk_bf16_f32 v181, v154, v155
v_cvt_pk_bf16_f32 v182, v156, v157
v_cvt_pk_bf16_f32 v183, v158, v159
v_add_f32 v12, v12, v146
ds_read_b128 v[236:239], v9 offset:39936
s_waitcnt lgkmcnt(4)
v_mfma_f32_32x32x16_bf16 v[96:111], v[220:223], v[176:179], v[96:111]
v_add_f32 v13, v13, v147
v_add_f32 v12, v12, v148
v_add_f32 v13, v13, v149
v_add_f32 v12, v12, v150
v_add_f32 v13, v13, v151
ds_read_b128 v[208:211], v9 offset:40960
s_waitcnt lgkmcnt(4)
v_mfma_f32_32x32x16_bf16 v[48:63], v[224:227], v[180:183], v[48:63]
v_exp_f32 v160, v160
v_exp_f32 v161, v161
v_exp_f32 v162, v162
v_exp_f32 v163, v163
v_exp_f32 v164, v164
ds_read_b128 v[212:215], v9 offset:43008
s_waitcnt lgkmcnt(4)
v_mfma_f32_32x32x16_bf16 v[64:79], v[228:231], v[180:183], v[64:79]
v_exp_f32 v165, v165
v_exp_f32 v166, v166
v_exp_f32 v167, v167
v_add_f32 v12, v12, v152
v_add_f32 v13, v13, v153
ds_read_b128 v[216:219], v9 offset:45056
s_waitcnt lgkmcnt(4)
v_mfma_f32_32x32x16_bf16 v[80:95], v[232:235], v[180:183], v[80:95]
v_cvt_pk_bf16_f32 v184, v160, v161
v_cvt_pk_bf16_f32 v185, v162, v163
v_cvt_pk_bf16_f32 v186, v164, v165
v_cvt_pk_bf16_f32 v187, v166, v167
v_add_f32 v12, v12, v154
ds_read_b128 v[220:223], v9 offset:47104
s_waitcnt lgkmcnt(4)
v_mfma_f32_32x32x16_bf16 v[96:111], v[236:239], v[180:183], v[96:111]
v_add_f32 v13, v13, v155
v_add_f32 v12, v12, v156
v_add_f32 v13, v13, v157
v_add_f32 v12, v12, v158
v_add_f32 v13, v13, v159
ds_read_b128 v[224:227], v9 offset:41984
s_waitcnt lgkmcnt(4)
v_mfma_f32_32x32x16_bf16 v[48:63], v[208:211], v[184:187], v[48:63]
v_exp_f32 v168, v168
v_exp_f32 v169, v169
v_exp_f32 v170, v170
v_exp_f32 v171, v171
v_exp_f32 v172, v172
ds_read_b128 v[228:231], v9 offset:44032
s_waitcnt lgkmcnt(4)
v_mfma_f32_32x32x16_bf16 v[64:79], v[212:215], v[184:187], v[64:79]
v_exp_f32 v173, v173
v_exp_f32 v174, v174
v_exp_f32 v175, v175
v_add_f32 v12, v12, v160
v_add_f32 v13, v13, v161
ds_read_b128 v[232:235], v9 offset:46080
s_waitcnt lgkmcnt(4)
v_mfma_f32_32x32x16_bf16 v[80:95], v[216:219], v[184:187], v[80:95]
v_cvt_pk_bf16_f32 v188, v168, v169
v_cvt_pk_bf16_f32 v189, v170, v171
v_cvt_pk_bf16_f32 v190, v172, v173
v_cvt_pk_bf16_f32 v191, v174, v175
v_add_f32 v12, v12, v162
ds_read_b128 v[236:239], v9 offset:48128
s_waitcnt lgkmcnt(4)
v_mfma_f32_32x32x16_bf16 v[96:111], v[220:223], v[184:187], v[96:111]
v_add_f32 v13, v13, v163
v_add_f32 v12, v12, v164
v_add_f32 v13, v13, v165
v_add_f32 v12, v12, v166
v_add_f32 v13, v13, v167
s_waitcnt lgkmcnt(3)
v_mfma_f32_32x32x16_bf16 v[48:63], v[224:227], v[188:191], v[48:63]
v_add_f32 v12, v12, v168
v_add_f32 v13, v13, v169
s_waitcnt lgkmcnt(2)
v_mfma_f32_32x32x16_bf16 v[64:79], v[228:231], v[188:191], v[64:79]
v_add_f32 v12, v12, v170
v_add_f32 v13, v13, v171
s_waitcnt lgkmcnt(1)
v_mfma_f32_32x32x16_bf16 v[80:95], v[232:235], v[188:191], v[80:95]
v_add_f32 v12, v12, v172
v_add_f32 v13, v13, v173
s_waitcnt lgkmcnt(0)
v_mfma_f32_32x32x16_bf16 v[96:111], v[236:239], v[188:191], v[96:111]
v_add_f32 v12, v12, v174
v_add_f32 v13, v13, v175
s_mov_b32 s4, 0x8000
.attn_F47:
v_add_f32 v12, v12, v13
v_mov_b32 v6, v12
s_nop 1
v_permlane32_swap_b32 v6, v12
s_nop 1
v_add_f32 v3, v12, v6
v_sub_f32 v2, 0, v192
s_lshl_b32 s5, s3, 9
s_add_u32 s5, s5, s4
v_lshl_add_u32 v4, v0, 3, s5
ds_write_b64 v4, v[2:3]
v_xor_b32 v4, 0x800, v4
s_lshl_b32 s5, s3, 13
s_add_u32 s5, s5, 0x10000
v_lshl_add_u32 v5, v0, 4, s5
s_barrier
s_cmp_eq_u32 s69, 0
s_cbranch_scc0 .attn_t3
.attn_t3:
s_cmp_eq_u32 s69, 0
s_cselect_b32 s4, s62, s7
s_lshl_b32 s4, s4, 2
s_add_u32 s4, s4, s61
s_lshl_b32 s4, s4, 18
s_lshl_b32 s5, s6, 13
s_add_u32 s4, s4, s5
s_lshl_b32 s5, s60, 12
s_add_u32 s70, s4, s5
s_cmp_eq_u32 s60, 0
s_cbranch_scc0 .attn_L56
ds_write_b128 v5, v[80:83] offset:0
ds_write_b128 v5, v[84:87] offset:1024
ds_write_b128 v5, v[88:91] offset:2048
ds_write_b128 v5, v[92:95] offset:3072
ds_write_b128 v5, v[96:99] offset:4096
ds_write_b128 v5, v[100:103] offset:5120
ds_write_b128 v5, v[104:107] offset:6144
ds_write_b128 v5, v[108:111] offset:7168
v_xor_b32 v5, 0x8000, v5
s_waitcnt lgkmcnt(0)
s_barrier
ds_read_b64 v[6:7], v4
ds_read_b128 v[112:115], v5 offset:0
ds_read_b128 v[116:119], v5 offset:1024
ds_read_b128 v[120:123], v5 offset:2048
ds_read_b128 v[124:127], v5 offset:3072
ds_read_b128 v[128:131], v5 offset:4096
ds_read_b128 v[132:135], v5 offset:5120
ds_read_b128 v[136:139], v5 offset:6144
ds_read_b128 v[140:143], v5 offset:7168
s_waitcnt lgkmcnt(8)
v_max_f32 v1, v2, v6
v_sub_f32 v2, v2, v1
v_sub_f32 v6, v6, v1
v_exp_f32 v2, v2
v_exp_f32 v6, v6
s_nop 0
v_mul_f32 v3, v2, v3
v_fmac_f32 v3, v6, v7
v_rcp_f32 v3, v3
s_nop 0
v_mul_f32 v2, v2, v3
v_mul_f32 v6, v6, v3
v_lshlrev_b32 v1, 4, v0
v_mul_f32 v48, v2, v48
v_mul_f32 v49, v2, v49
v_mul_f32 v50, v2, v50
v_mul_f32 v51, v2, v51
v_mul_f32 v52, v2, v52
v_mul_f32 v53, v2, v53
v_mul_f32 v54, v2, v54
v_mul_f32 v55, v2, v55
v_mul_f32 v56, v2, v56
v_mul_f32 v57, v2, v57
v_mul_f32 v58, v2, v58
v_mul_f32 v59, v2, v59
v_mul_f32 v60, v2, v60
v_mul_f32 v61, v2, v61
v_mul_f32 v62, v2, v62
v_mul_f32 v63, v2, v63
v_mul_f32 v64, v2, v64
v_mul_f32 v65, v2, v65
v_mul_f32 v66, v2, v66
v_mul_f32 v67, v2, v67
v_mul_f32 v68, v2, v68
v_mul_f32 v69, v2, v69
v_mul_f32 v70, v2, v70
v_mul_f32 v71, v2, v71
v_mul_f32 v72, v2, v72
v_mul_f32 v73, v2, v73
v_mul_f32 v74, v2, v74
v_mul_f32 v75, v2, v75
v_mul_f32 v76, v2, v76
v_mul_f32 v77, v2, v77
v_mul_f32 v78, v2, v78
v_mul_f32 v79, v2, v79
s_waitcnt lgkmcnt(0)
s_barrier
s_cmp_lg_u32 s69, 0
s_cbranch_scc1 .attn_L58
s_mov_b32 s68, s7
s_cmp_gt_u32 s68, 0
s_cselect_b32 s18, s18, 0
s_add_u32 m0, s63, 32768
s_nop 0
buffer_load_dwordx4 v10, s[16:19], s66 offen offset:0 lds
buffer_load_dwordx4 v10, s[16:19], s66 offen offset:1024 lds
buffer_load_dwordx4 v10, s[16:19], s66 offen offset:2048 lds
buffer_load_dwordx4 v10, s[16:19], s66 offen offset:3072 lds
s_add_u32 s66, s66, 32768
s_add_u32 m0, s65, 0
s_nop 0
buffer_load_dwordx4 v10, s[20:23], s67 offen offset:0 lds
buffer_load_dwordx4 v10, s[20:23], s67 offen offset:1024 lds
buffer_load_dwordx4 v10, s[20:23], s67 offen offset:2048 lds
buffer_load_dwordx4 v10, s[20:23], s67 offen offset:3072 lds
s_add_u32 s67, s67, 32768
.attn_L58:
v_fmac_f32 v48, v6, v112
v_fmac_f32 v49, v6, v113
v_fmac_f32 v50, v6, v114
v_fmac_f32 v51, v6, v115
v_fmac_f32 v52, v6, v116
v_fmac_f32 v53, v6, v117
v_fmac_f32 v54, v6, v118
v_fmac_f32 v55, v6, v119
v_fmac_f32 v56, v6, v120
v_fmac_f32 v57, v6, v121
v_fmac_f32 v58, v6, v122
v_fmac_f32 v59, v6, v123
v_fmac_f32 v60, v6, v124
v_fmac_f32 v61, v6, v125
v_fmac_f32 v62, v6, v126
v_fmac_f32 v63, v6, v127
v_fmac_f32 v64, v6, v128
v_fmac_f32 v65, v6, v129
v_fmac_f32 v66, v6, v130
v_fmac_f32 v67, v6, v131
v_fmac_f32 v68, v6, v132
v_fmac_f32 v69, v6, v133
v_fmac_f32 v70, v6, v134
v_fmac_f32 v71, v6, v135
v_fmac_f32 v72, v6, v136
v_fmac_f32 v73, v6, v137
v_fmac_f32 v74, v6, v138
v_fmac_f32 v75, v6, v139
v_fmac_f32 v76, v6, v140
v_fmac_f32 v77, v6, v141
v_fmac_f32 v78, v6, v142
v_fmac_f32 v79, v6, v143
v_cvt_pk_bf16_f32 v176, v48, v49
v_cvt_pk_bf16_f32 v177, v50, v51
v_cvt_pk_bf16_f32 v178, v52, v53
v_cvt_pk_bf16_f32 v179, v54, v55
buffer_store_dwordx4 v[176:179], v1, s[24:27], s70 offen offset:0 sc1
v_cvt_pk_bf16_f32 v180, v56, v57
v_cvt_pk_bf16_f32 v181, v58, v59
v_cvt_pk_bf16_f32 v182, v60, v61
v_cvt_pk_bf16_f32 v183, v62, v63
buffer_store_dwordx4 v[180:183], v1, s[24:27], s70 offen offset:1024 sc1
v_cvt_pk_bf16_f32 v184, v64, v65
v_cvt_pk_bf16_f32 v185, v66, v67
v_cvt_pk_bf16_f32 v186, v68, v69
v_cvt_pk_bf16_f32 v187, v70, v71
buffer_store_dwordx4 v[184:187], v1, s[24:27], s70 offen offset:2048 sc1
v_cvt_pk_bf16_f32 v188, v72, v73
v_cvt_pk_bf16_f32 v189, v74, v75
v_cvt_pk_bf16_f32 v190, v76, v77
v_cvt_pk_bf16_f32 v191, v78, v79
buffer_store_dwordx4 v[188:191], v1, s[24:27], s70 offen offset:3072 sc1
s_branch .attn_L57
.attn_L56:
ds_write_b128 v5, v[48:51] offset:0
ds_write_b128 v5, v[52:55] offset:1024
ds_write_b128 v5, v[56:59] offset:2048
ds_write_b128 v5, v[60:63] offset:3072
ds_write_b128 v5, v[64:67] offset:4096
ds_write_b128 v5, v[68:71] offset:5120
ds_write_b128 v5, v[72:75] offset:6144
ds_write_b128 v5, v[76:79] offset:7168
v_xor_b32 v5, 0x8000, v5
s_waitcnt lgkmcnt(0)
s_barrier
ds_read_b64 v[6:7], v4
ds_read_b128 v[112:115], v5 offset:0
ds_read_b128 v[116:119], v5 offset:1024
ds_read_b128 v[120:123], v5 offset:2048
ds_read_b128 v[124:127], v5 offset:3072
ds_read_b128 v[128:131], v5 offset:4096
ds_read_b128 v[132:135], v5 offset:5120
ds_read_b128 v[136:139], v5 offset:6144
ds_read_b128 v[140:143], v5 offset:7168
s_waitcnt lgkmcnt(8)
v_max_f32 v1, v2, v6
v_sub_f32 v2, v2, v1
v_sub_f32 v6, v6, v1
v_exp_f32 v2, v2
v_exp_f32 v6, v6
s_nop 0
v_mul_f32 v3, v2, v3
v_fmac_f32 v3, v6, v7
v_rcp_f32 v3, v3
s_nop 0
v_mul_f32 v2, v2, v3
v_mul_f32 v6, v6, v3
v_lshlrev_b32 v1, 4, v0
v_mul_f32 v80, v2, v80
v_mul_f32 v81, v2, v81
v_mul_f32 v82, v2, v82
v_mul_f32 v83, v2, v83
v_mul_f32 v84, v2, v84
v_mul_f32 v85, v2, v85
v_mul_f32 v86, v2, v86
v_mul_f32 v87, v2, v87
v_mul_f32 v88, v2, v88
v_mul_f32 v89, v2, v89
v_mul_f32 v90, v2, v90
v_mul_f32 v91, v2, v91
v_mul_f32 v92, v2, v92
v_mul_f32 v93, v2, v93
v_mul_f32 v94, v2, v94
v_mul_f32 v95, v2, v95
v_mul_f32 v96, v2, v96
v_mul_f32 v97, v2, v97
v_mul_f32 v98, v2, v98
v_mul_f32 v99, v2, v99
v_mul_f32 v100, v2, v100
v_mul_f32 v101, v2, v101
v_mul_f32 v102, v2, v102
v_mul_f32 v103, v2, v103
v_mul_f32 v104, v2, v104
v_mul_f32 v105, v2, v105
v_mul_f32 v106, v2, v106
v_mul_f32 v107, v2, v107
v_mul_f32 v108, v2, v108
v_mul_f32 v109, v2, v109
v_mul_f32 v110, v2, v110
v_mul_f32 v111, v2, v111
s_waitcnt lgkmcnt(0)
s_barrier
s_cmp_lg_u32 s69, 0
s_cbranch_scc1 .attn_L59
s_mov_b32 s68, s7
s_cmp_gt_u32 s68, 0
s_cselect_b32 s18, s18, 0
s_add_u32 m0, s63, 32768
s_nop 0
buffer_load_dwordx4 v10, s[16:19], s66 offen offset:0 lds
buffer_load_dwordx4 v10, s[16:19], s66 offen offset:1024 lds
buffer_load_dwordx4 v10, s[16:19], s66 offen offset:2048 lds
buffer_load_dwordx4 v10, s[16:19], s66 offen offset:3072 lds
s_add_u32 s66, s66, 32768
s_add_u32 m0, s65, 0
s_nop 0
buffer_load_dwordx4 v10, s[20:23], s67 offen offset:0 lds
buffer_load_dwordx4 v10, s[20:23], s67 offen offset:1024 lds
buffer_load_dwordx4 v10, s[20:23], s67 offen offset:2048 lds
buffer_load_dwordx4 v10, s[20:23], s67 offen offset:3072 lds
s_add_u32 s67, s67, 32768
.attn_L59:
v_fmac_f32 v80, v6, v112
v_fmac_f32 v81, v6, v113
v_fmac_f32 v82, v6, v114
v_fmac_f32 v83, v6, v115
v_fmac_f32 v84, v6, v116
v_fmac_f32 v85, v6, v117
v_fmac_f32 v86, v6, v118
v_fmac_f32 v87, v6, v119
v_fmac_f32 v88, v6, v120
v_fmac_f32 v89, v6, v121
v_fmac_f32 v90, v6, v122
v_fmac_f32 v91, v6, v123
v_fmac_f32 v92, v6, v124
v_fmac_f32 v93, v6, v125
v_fmac_f32 v94, v6, v126
v_fmac_f32 v95, v6, v127
v_fmac_f32 v96, v6, v128
v_fmac_f32 v97, v6, v129
v_fmac_f32 v98, v6, v130
v_fmac_f32 v99, v6, v131
v_fmac_f32 v100, v6, v132
v_fmac_f32 v101, v6, v133
v_fmac_f32 v102, v6, v134
v_fmac_f32 v103, v6, v135
v_fmac_f32 v104, v6, v136
v_fmac_f32 v105, v6, v137
v_fmac_f32 v106, v6, v138
v_fmac_f32 v107, v6, v139
v_fmac_f32 v108, v6, v140
v_fmac_f32 v109, v6, v141
v_fmac_f32 v110, v6, v142
v_fmac_f32 v111, v6, v143
v_cvt_pk_bf16_f32 v176, v80, v81
v_cvt_pk_bf16_f32 v177, v82, v83
v_cvt_pk_bf16_f32 v178, v84, v85
v_cvt_pk_bf16_f32 v179, v86, v87
buffer_store_dwordx4 v[176:179], v1, s[24:27], s70 offen offset:0 sc1
v_cvt_pk_bf16_f32 v180, v88, v89
v_cvt_pk_bf16_f32 v181, v90, v91
v_cvt_pk_bf16_f32 v182, v92, v93
v_cvt_pk_bf16_f32 v183, v94, v95
buffer_store_dwordx4 v[180:183], v1, s[24:27], s70 offen offset:1024 sc1
v_cvt_pk_bf16_f32 v184, v96, v97
v_cvt_pk_bf16_f32 v185, v98, v99
v_cvt_pk_bf16_f32 v186, v100, v101
v_cvt_pk_bf16_f32 v187, v102, v103
buffer_store_dwordx4 v[184:187], v1, s[24:27], s70 offen offset:2048 sc1
v_cvt_pk_bf16_f32 v188, v104, v105
v_cvt_pk_bf16_f32 v189, v106, v107
v_cvt_pk_bf16_f32 v190, v108, v109
v_cvt_pk_bf16_f32 v191, v110, v111
buffer_store_dwordx4 v[188:191], v1, s[24:27], s70 offen offset:3072 sc1
.attn_L57:
s_cmp_lg_u32 s69, 0
s_cbranch_scc0 .attn_nw
s_waitcnt vmcnt(0)
.attn_nw:
s_cbranch_scc1 .attn_end
s_mov_b32 s69, 1
v_add_u32 v15, 0x8000, v15
s_waitcnt vmcnt(12)
s_branch .attn_B41
.attn_end:
s_endpgm
.globl oproj_kernel
.p2align 8
.type oproj_kernel,@function
oproj_kernel:
s_cmp_ge_u32 s2, 240
s_cbranch_scc1 .oproj_end
v_readfirstlane_b32 s3, v0
v_and_b32 v0, 63, v0
s_lshr_b32 s3, s3, 6
s_and_b32 s4, s2, 7
s_mul_i32 s4, s4, 30
s_lshr_b32 s5, s2, 3
s_add_u32 s4, s4, s5
s_mul_i32 s5, s4, 171
s_lshr_b32 s5, s5, 9
s_mul_i32 s6, s5, 3
s_sub_u32 s61, s4, s6
s_lshr_b32 s60, s5, 4
s_and_b32 s62, s5, 15
s_and_b32 s68, s62, 3
s_load_dwordx2 s[8:9], s[0:1], 40
s_load_dwordx2 s[12:13], s[0:1], 104
s_load_dwordx2 s[16:17], s[0:1], 104
s_mul_i32 s63, s60, 13
s_cmp_eq_u32 s60, 4
s_cselect_b32 s64, 12, 13
s_mul_i32 s50, s63, 73728
s_mul_i32 s4, s61, 384
s_add_u32 s50, s50, s4
s_lshl_b32 s51, s62, 20
s_lshl_b32 s4, s63, 12
s_add_u32 s51, s51, s4
s_and_b32 s56, s3, 1
s_mul_i32 s56, s56, 3
s_and_b32 s57, s3, 2
s_cmp_lt_u32 s3, 4
s_cbranch_scc1 .oproj_L1
s_sub_u32 s3, s3, 4
s_mul_i32 s4, s3, 6
s_add_u32 s4, s4, 0
s_lshl_b32 s4, s4, 6
v_add_u32 v1, s4, v0
v_mul_u32_u24 v2, 2731, v1
v_lshrrev_b32 v2, 16, v2
v_mul_u32_u24 v3, 24, v2
v_sub_u32 v3, v1, v3
v_and_b32 v4, 2, v2
v_lshlrev_b32 v4, 1, v4
v_xor_b32 v3, v3, v4
v_mul_u32_u24 v2, 1152, v2
v_lshl_add_u32 v8, v3, 4, v2
s_mul_i32 s4, s3, 6
s_add_u32 s4, s4, 1
s_lshl_b32 s4, s4, 6
v_add_u32 v1, s4, v0
v_mul_u32_u24 v2, 2731, v1
v_lshrrev_b32 v2, 16, v2
v_mul_u32_u24 v3, 24, v2
v_sub_u32 v3, v1, v3
v_and_b32 v4, 2, v2
v_lshlrev_b32 v4, 1, v4
v_xor_b32 v3, v3, v4
v_mul_u32_u24 v2, 1152, v2
v_lshl_add_u32 v9, v3, 4, v2
s_mul_i32 s4, s3, 6
s_add_u32 s4, s4, 2
s_lshl_b32 s4, s4, 6
v_add_u32 v1, s4, v0
v_mul_u32_u24 v2, 2731, v1
v_lshrrev_b32 v2, 16, v2
v_mul_u32_u24 v3, 24, v2
v_sub_u32 v3, v1, v3
v_and_b32 v4, 2, v2
v_lshlrev_b32 v4, 1, v4
v_xor_b32 v3, v3, v4
v_mul_u32_u24 v2, 1152, v2
v_lshl_add_u32 v10, v3, 4, v2
s_mul_i32 s4, s3, 6
s_add_u32 s4, s4, 3
s_lshl_b32 s4, s4, 6
v_add_u32 v1, s4, v0
v_mul_u32_u24 v2, 2731, v1
v_lshrrev_b32 v2, 16, v2
v_mul_u32_u24 v3, 24, v2
v_sub_u32 v3, v1, v3
v_and_b32 v4, 2, v2
v_lshlrev_b32 v4, 1, v4
v_xor_b32 v3, v3, v4
v_mul_u32_u24 v2, 1152, v2
v_lshl_add_u32 v11, v3, 4, v2
s_mul_i32 s4, s3, 6
s_add_u32 s4, s4, 4
s_lshl_b32 s4, s4, 6
v_add_u32 v1, s4, v0
v_mul_u32_u24 v2, 2731, v1
v_lshrrev_b32 v2, 16, v2
v_mul_u32_u24 v3, 24, v2
v_sub_u32 v3, v1, v3
v_and_b32 v4, 2, v2
v_lshlrev_b32 v4, 1, v4
v_xor_b32 v3, v3, v4
v_mul_u32_u24 v2, 1152, v2
v_lshl_add_u32 v12, v3, 4, v2
s_mul_i32 s4, s3, 6
s_add_u32 s4, s4, 5
s_lshl_b32 s4, s4, 6
v_add_u32 v1, s4, v0
v_mul_u32_u24 v2, 2731, v1
v_lshrrev_b32 v2, 16, v2
v_mul_u32_u24 v3, 24, v2
v_sub_u32 v3, v1, v3
v_and_b32 v4, 2, v2
v_lshlrev_b32 v4, 1, v4
v_xor_b32 v3, v3, v4
v_mul_u32_u24 v2, 1152, v2
v_lshl_add_u32 v13, v3, 4, v2
s_mul_i32 s53, s3, 6144
s_add_u32 s53, s53, 0
s_mul_i32 s4, s3, 4
s_add_u32 s4, s4, 0
s_lshr_b32 s5, s4, 2
s_mul_i32 s5, s5, 262144
s_and_b32 s4, s4, 3
s_lshl_b32 s4, s4, 10
s_add_u32 s4, s4, s5
v_lshl_add_u32 v14, v0, 4, s4
s_mul_i32 s4, s3, 4
s_add_u32 s4, s4, 1
s_lshr_b32 s5, s4, 2
s_mul_i32 s5, s5, 262144
s_and_b32 s4, s4, 3
s_lshl_b32 s4, s4, 10
s_add_u32 s4, s4, s5
v_lshl_add_u32 v15, v0, 4, s4
s_mul_i32 s4, s3, 4
s_add_u32 s4, s4, 2
s_lshr_b32 s5, s4, 2
s_mul_i32 s5, s5, 262144
s_and_b32 s4, s4, 3
s_lshl_b32 s4, s4, 10
s_add_u32 s4, s4, s5
v_lshl_add_u32 v16, v0, 4, s4
s_mul_i32 s4, s3, 4
s_add_u32 s4, s4, 3
s_lshr_b32 s5, s4, 2
s_mul_i32 s5, s5, 262144
s_and_b32 s4, s4, 3
s_lshl_b32 s4, s4, 10
s_add_u32 s4, s4, s5
v_lshl_add_u32 v17, v0, 4, s4
s_mul_i32 s54, s3, 4096
s_add_u32 s54, s54, 24576
s_waitcnt lgkmcnt(0)
s_mov_b32 s10, 4718592
s_mov_b32 s11, 0x20000
s_add_u32 s12, s12, 37814272
s_addc_u32 s13, s13, 0
s_mov_b32 s14, 16777216
s_mov_b32 s15, 0x20000
s_add_u32 s16, s16, 4194304
s_addc_u32 s17, s17, 0
s_mov_b32 s18, 11796480
s_mov_b32 s19, 0x20000
s_mov_b32 s40, s64
s_mov_b32 s44, s64
s_mov_b32 s41, 0
s_mov_b32 s43, 0
s_mov_b32 s45, 40960
s_cmp_gt_i32 s44, 0
s_cselect_b32 s10, s10, 0
s_cselect_b32 s14, s14, 0
s_sub_u32 s44, s44, 1
s_add_u32 m0, s41, s53
s_nop 0
buffer_load_dwordx4 v8, s[8:11], s50 offen lds
s_add_u32 m0, m0, 1024
s_nop 0
buffer_load_dwordx4 v9, s[8:11], s50 offen lds
s_add_u32 m0, m0, 1024
s_nop 0
buffer_load_dwordx4 v10, s[8:11], s50 offen lds
s_add_u32 m0, m0, 1024
s_nop 0
buffer_load_dwordx4 v11, s[8:11], s50 offen lds
s_add_u32 m0, m0, 1024
s_nop 0
buffer_load_dwordx4 v12, s[8:11], s50 offen lds
s_add_u32 m0, m0, 1024
s_nop 0
buffer_load_dwordx4 v13, s[8:11], s50 offen lds
s_add_u32 s50, s50, 73728
s_add_u32 m0, s41, s54
s_nop 0
buffer_load_dwordx4 v14, s[12:15], s51 offen lds
s_add_u32 m0, m0, 1024
s_nop 0
buffer_load_dwordx4 v15, s[12:15], s51 offen lds
s_add_u32 m0, m0, 1024
s_nop 0
buffer_load_dwordx4 v16, s[12:15], s51 offen lds
s_add_u32 m0, m0, 1024
s_nop 0
buffer_load_dwordx4 v17, s[12:15], s51 offen lds
s_add_u32 s51, s51, 4096
s_add_u32 s41, s41, 40960
s_cmp_eq_u32 s41, 163840
s_cselect_b32 s41, 0, s41
s_cmp_gt_i32 s44, 0
s_cselect_b32 s10, s10, 0
s_cselect_b32 s14, s14, 0
s_sub_u32 s44, s44, 1
s_add_u32 m0, s41, s53
s_nop 0
buffer_load_dwordx4 v8, s[8:11], s50 offen lds
s_add_u32 m0, m0, 1024
s_nop 0
buffer_load_dwordx4 v9, s[8:11], s50 offen lds
s_add_u32 m0, m0, 1024
s_nop 0
buffer_load_dwordx4 v10, s[8:11], s50 offen lds
s_add_u32 m0, m0, 1024
s_nop 0
buffer_load_dwordx4 v11, s[8:11], s50 offen lds
s_add_u32 m0, m0, 1024
s_nop 0
buffer_load_dwordx4 v12, s[8:11], s50 offen lds
s_add_u32 m0, m0, 1024
s_nop 0
buffer_load_dwordx4 v13, s[8:11], s50 offen lds
s_add_u32 s50, s50, 73728
s_add_u32 m0, s41, s54
s_nop 0
buffer_load_dwordx4 v14, s[12:15], s51 offen lds
s_add_u32 m0, m0, 1024
s_nop 0
buffer_load_dwordx4 v15, s[12:15], s51 offen lds
s_add_u32 m0, m0, 1024
s_nop 0
buffer_load_dwordx4 v16, s[12:15], s51 offen lds
s_add_u32 m0, m0, 1024
s_nop 0
buffer_load_dwordx4 v17, s[12:15], s51 offen lds
s_add_u32 s51, s51, 4096
s_add_u32 s41, s41, 40960
s_cmp_eq_u32 s41, 163840
s_cselect_b32 s41, 0, s41
s_cmp_gt_i32 s44, 0
s_cselect_b32 s10, s10, 0
s_cselect_b32 s14, s14, 0
s_sub_u32 s44, s44, 1
s_add_u32 m0, s41, s53
s_nop 0
buffer_load_dwordx4 v8, s[8:11], s50 offen lds
s_add_u32 m0, m0, 1024
s_nop 0
buffer_load_dwordx4 v9, s[8:11], s50 offen lds
s_add_u32 m0, m0, 1024
s_nop 0
buffer_load_dwordx4 v10, s[8:11], s50 offen lds
s_add_u32 m0, m0, 1024
s_nop 0
buffer_load_dwordx4 v11, s[8:11], s50 offen lds
s_add_u32 m0, m0, 1024
s_nop 0
buffer_load_dwordx4 v12, s[8:11], s50 offen lds
s_add_u32 m0, m0, 1024
s_nop 0
buffer_load_dwordx4 v13, s[8:11], s50 offen lds
s_add_u32 s50, s50, 73728
s_add_u32 m0, s41, s54
s_nop 0
buffer_load_dwordx4 v14, s[12:15], s51 offen lds
s_add_u32 m0, m0, 1024
s_nop 0
buffer_load_dwordx4 v15, s[12:15], s51 offen lds
s_add_u32 m0, m0, 1024
s_nop 0
buffer_load_dwordx4 v16, s[12:15], s51 offen lds
s_add_u32 m0, m0, 1024
s_nop 0
buffer_load_dwordx4 v17, s[12:15], s51 offen lds
s_add_u32 s51, s51, 4096
s_add_u32 s41, s41, 40960
s_cmp_eq_u32 s41, 163840
s_cselect_b32 s41, 0, s41
s_cmp_gt_i32 s44, 0
s_cselect_b32 s10, s10, 0
s_cselect_b32 s14, s14, 0
s_sub_u32 s44, s44, 1
s_add_u32 m0, s41, s53
s_nop 0
buffer_load_dwordx4 v8, s[8:11], s50 offen lds
s_add_u32 m0, m0, 1024
s_nop 0
buffer_load_dwordx4 v9, s[8:11], s50 offen lds
s_add_u32 m0, m0, 1024
s_nop 0
buffer_load_dwordx4 v10, s[8:11], s50 offen lds
s_add_u32 m0, m0, 1024
s_nop 0
buffer_load_dwordx4 v11, s[8:11], s50 offen lds
s_add_u32 m0, m0, 1024
s_nop 0
buffer_load_dwordx4 v12, s[8:11], s50 offen lds
s_add_u32 m0, m0, 1024
s_nop 0
buffer_load_dwordx4 v13, s[8:11], s50 offen lds
s_add_u32 s50, s50, 73728
s_add_u32 m0, s41, s54
s_nop 0
buffer_load_dwordx4 v14, s[12:15], s51 offen lds
s_add_u32 m0, m0, 1024
s_nop 0
buffer_load_dwordx4 v15, s[12:15], s51 offen lds
s_add_u32 m0, m0, 1024
s_nop 0
buffer_load_dwordx4 v16, s[12:15], s51 offen lds
s_add_u32 m0, m0, 1024
s_nop 0
buffer_load_dwordx4 v17, s[12:15], s51 offen lds
s_add_u32 s51, s51, 4096
s_add_u32 s41, s41, 40960
s_cmp_eq_u32 s41, 163840
s_cselect_b32 s41, 0, s41
s_waitcnt vmcnt(30)
s_barrier
.oproj_L2:
s_waitcnt vmcnt(20)
s_barrier
s_cmp_gt_i32 s44, 0
s_cselect_b32 s10, s10, 0
s_cselect_b32 s14, s14, 0
s_sub_u32 s44, s44, 1
s_add_u32 m0, s41, s53
s_nop 0
buffer_load_dwordx4 v8, s[8:11], s50 offen lds
s_add_u32 m0, m0, 1024
s_nop 0
buffer_load_dwordx4 v9, s[8:11], s50 offen lds
s_add_u32 m0, m0, 1024
s_nop 0
buffer_load_dwordx4 v10, s[8:11], s50 offen lds
s_add_u32 m0, m0, 1024
s_nop 0
buffer_load_dwordx4 v11, s[8:11], s50 offen lds
s_add_u32 m0, m0, 1024
s_nop 0
buffer_load_dwordx4 v12, s[8:11], s50 offen lds
s_add_u32 m0, m0, 1024
s_nop 0
buffer_load_dwordx4 v13, s[8:11], s50 offen lds
s_add_u32 s50, s50, 73728
s_add_u32 m0, s41, s54
s_nop 0
buffer_load_dwordx4 v14, s[12:15], s51 offen lds
s_add_u32 m0, m0, 1024
s_nop 0
buffer_load_dwordx4 v15, s[12:15], s51 offen lds
s_add_u32 m0, m0, 1024
s_nop 0
buffer_load_dwordx4 v16, s[12:15], s51 offen lds
s_add_u32 m0, m0, 1024
s_nop 0
buffer_load_dwordx4 v17, s[12:15], s51 offen lds
s_add_u32 s51, s51, 4096
s_add_u32 s41, s41, 40960
s_cmp_eq_u32 s41, 163840
s_cselect_b32 s41, 0, s41
s_sub_u32 s40, s40, 1
s_cmp_lg_u32 s40, 0
s_cbranch_scc1 .oproj_L2
s_waitcnt vmcnt(0) lgkmcnt(0)
s_nop 7
s_nop 7
s_endpgm
.oproj_L1:
v_bfe_u32 v1, v0, 2, 2
v_lshrrev_b32 v2, 5, v0
v_lshl_add_u32 v2, v2, 2, v1
v_mul_u32_u24 v2, 384, v2
v_bfe_u32 v3, v0, 4, 1
v_lshl_add_u32 v2, v3, 5, v2
v_and_b32 v3, 3, v0
v_lshl_add_u32 v2, v3, 3, v2
v_add_u32 v2, 0, v2
v_lshrrev_b32 v1, 1, v1
s_add_u32 s4, s56, 0
v_xor_b32 v3, s4, v1
v_lshl_add_u32 v8, v3, 6, v2
s_add_u32 s4, s56, 1
v_xor_b32 v3, s4, v1
v_lshl_add_u32 v9, v3, 6, v2
s_add_u32 s4, s56, 2
v_xor_b32 v3, s4, v1
v_lshl_add_u32 v10, v3, 6, v2
s_lshl_b32 s4, s57, 12
s_add_u32 s4, s4, 24576
v_lshl_add_u32 v11, v0, 4, s4
s_waitcnt lgkmcnt(0)
s_mov_b32 s10, 4718592
s_mov_b32 s11, 0x20000
s_add_u32 s12, s12, 37814272
s_addc_u32 s13, s13, 0
s_mov_b32 s14, 16777216
s_mov_b32 s15, 0x20000
s_add_u32 s16, s16, 4194304
s_addc_u32 s17, s17, 0
s_mov_b32 s18, 11796480
s_mov_b32 s19, 0x20000
s_mov_b32 s40, s64
s_mov_b32 s44, s64
s_mov_b32 s41, 0
s_mov_b32 s43, 0
s_mov_b32 s45, 40960
v_mov_b32 v64, 0
v_mov_b32 v65, 0
v_mov_b32 v66, 0
v_mov_b32 v67, 0
v_mov_b32 v68, 0
v_mov_b32 v69, 0
v_mov_b32 v70, 0
v_mov_b32 v71, 0
v_mov_b32 v72, 0
v_mov_b32 v73, 0
v_mov_b32 v74, 0
v_mov_b32 v75, 0
v_mov_b32 v76, 0
v_mov_b32 v77, 0
v_mov_b32 v78, 0
v_mov_b32 v79, 0
v_mov_b32 v80, 0
v_mov_b32 v81, 0
v_mov_b32 v82, 0
v_mov_b32 v83, 0
v_mov_b32 v84, 0
v_mov_b32 v85, 0
v_mov_b32 v86, 0
v_mov_b32 v87, 0
v_mov_b32 v88, 0
v_mov_b32 v89, 0
v_mov_b32 v90, 0
v_mov_b32 v91, 0
v_mov_b32 v92, 0
v_mov_b32 v93, 0
v_mov_b32 v94, 0
v_mov_b32 v95, 0
v_mov_b32 v96, 0
v_mov_b32 v97, 0
v_mov_b32 v98, 0
v_mov_b32 v99, 0
v_mov_b32 v100, 0
v_mov_b32 v101, 0
v_mov_b32 v102, 0
v_mov_b32 v103, 0
v_mov_b32 v104, 0
v_mov_b32 v105, 0
v_mov_b32 v106, 0
v_mov_b32 v107, 0
v_mov_b32 v108, 0
v_mov_b32 v109, 0
v_mov_b32 v110, 0
v_mov_b32 v111, 0
v_mov_b32 v112, 0
v_mov_b32 v113, 0
v_mov_b32 v114, 0
v_mov_b32 v115, 0
v_mov_b32 v116, 0
v_mov_b32 v117, 0
v_mov_b32 v118, 0
v_mov_b32 v119, 0
v_mov_b32 v120, 0
v_mov_b32 v121, 0
v_mov_b32 v122, 0
v_mov_b32 v123, 0
v_mov_b32 v124, 0
v_mov_b32 v125, 0
v_mov_b32 v126, 0
v_mov_b32 v127, 0
v_mov_b32 v128, 0
v_mov_b32 v129, 0
v_mov_b32 v130, 0
v_mov_b32 v131, 0
v_mov_b32 v132, 0
v_mov_b32 v133, 0
v_mov_b32 v134, 0
v_mov_b32 v135, 0
v_mov_b32 v136, 0
v_mov_b32 v137, 0
v_mov_b32 v138, 0
v_mov_b32 v139, 0
v_mov_b32 v140, 0
v_mov_b32 v141, 0
v_mov_b32 v142, 0
v_mov_b32 v143, 0
v_mov_b32 v144, 0
v_mov_b32 v145, 0
v_mov_b32 v146, 0
v_mov_b32 v147, 0
v_mov_b32 v148, 0
v_mov_b32 v149, 0
v_mov_b32 v150, 0
v_mov_b32 v151, 0
v_mov_b32 v152, 0
v_mov_b32 v153, 0
v_mov_b32 v154, 0
v_mov_b32 v155, 0
v_mov_b32 v156, 0
v_mov_b32 v157, 0
v_mov_b32 v158, 0
v_mov_b32 v159, 0
s_barrier
ds_read_b64_tr_b16 v[24:25], v8 offset:0
ds_read_b64_tr_b16 v[26:27], v8 offset:3072
ds_read_b64_tr_b16 v[28:29], v9 offset:0
ds_read_b64_tr_b16 v[30:31], v9 offset:3072
ds_read_b64_tr_b16 v[32:33], v10 offset:0
ds_read_b64_tr_b16 v[34:35], v10 offset:3072
ds_read_b128 v[36:39], v11 offset:0
ds_read_b128 v[40:43], v11 offset:4096
.oproj_L3:
ds_read_b64_tr_b16 v[44:45], v8 offset:6144
ds_read_b64_tr_b16 v[46:47], v8 offset:9216
ds_read_b64_tr_b16 v[48:49], v9 offset:6144
s_waitcnt lgkmcnt(3)
v_mfma_f32_32x32x16_bf16 v[64:79], v[24:27], v[36:39], v[64:79]
ds_read_b64_tr_b16 v[50:51], v9 offset:9216
ds_read_b64_tr_b16 v[52:53], v10 offset:6144
v_mfma_f32_32x32x16_bf16 v[80:95], v[24:27], v[40:43], v[80:95]
ds_read_b64_tr_b16 v[54:55], v10 offset:9216
ds_read_b128 v[56:59], v11 offset:1024
v_mfma_f32_32x32x16_bf16 v[96:111], v[28:31], v[36:39], v[96:111]
ds_read_b128 v[60:63], v11 offset:5120
v_mfma_f32_32x32x16_bf16 v[112:127], v[28:31], v[40:43], v[112:127]
v_mfma_f32_32x32x16_bf16 v[128:143], v[32:35], v[36:39], v[128:143]
v_mfma_f32_32x32x16_bf16 v[144:159], v[32:35], v[40:43], v[144:159]
ds_read_b64_tr_b16 v[24:25], v8 offset:12288
ds_read_b64_tr_b16 v[26:27], v8 offset:15360
ds_read_b64_tr_b16 v[28:29], v9 offset:12288
s_waitcnt lgkmcnt(3)
v_mfma_f32_32x32x16_bf16 v[64:79], v[44:47], v[56:59], v[64:79]
ds_read_b64_tr_b16 v[30:31], v9 offset:15360
ds_read_b64_tr_b16 v[32:33], v10 offset:12288
v_mfma_f32_32x32x16_bf16 v[80:95], v[44:47], v[60:63], v[80:95]
ds_read_b64_tr_b16 v[34:35], v10 offset:15360
ds_read_b128 v[36:39], v11 offset:2048
v_mfma_f32_32x32x16_bf16 v[96:111], v[48:51], v[56:59], v[96:111]
ds_read_b128 v[40:43], v11 offset:6144
v_mfma_f32_32x32x16_bf16 v[112:127], v[48:51], v[60:63], v[112:127]
v_mfma_f32_32x32x16_bf16 v[128:143], v[52:55], v[56:59], v[128:143]
v_mfma_f32_32x32x16_bf16 v[144:159], v[52:55], v[60:63], v[144:159]
ds_read_b64_tr_b16 v[44:45], v8 offset:18432
ds_read_b64_tr_b16 v[46:47], v8 offset:21504
ds_read_b64_tr_b16 v[48:49], v9 offset:18432
s_waitcnt lgkmcnt(3)
v_mfma_f32_32x32x16_bf16 v[64:79], v[24:27], v[36:39], v[64:79]
ds_read_b64_tr_b16 v[50:51], v9 offset:21504
ds_read_b64_tr_b16 v[52:53], v10 offset:18432
v_mfma_f32_32x32x16_bf16 v[80:95], v[24:27], v[40:43], v[80:95]
ds_read_b64_tr_b16 v[54:55], v10 offset:21504
ds_read_b128 v[56:59], v11 offset:3072
v_mfma_f32_32x32x16_bf16 v[96:111], v[28:31], v[36:39], v[96:111]
ds_read_b128 v[60:63], v11 offset:7168
v_mfma_f32_32x32x16_bf16 v[112:127], v[28:31], v[40:43], v[112:127]
v_mfma_f32_32x32x16_bf16 v[128:143], v[32:35], v[36:39], v[128:143]
v_mfma_f32_32x32x16_bf16 v[144:159], v[32:35], v[40:43], v[144:159]
s_add_u32 s43, s43, 40960
s_cmp_eq_u32 s43, 163840
s_cselect_b32 s42, -122880, s45
s_cselect_b32 s43, 0, s43
s_waitcnt lgkmcnt(0)
v_add_u32 v8, s42, v8
v_add_u32 v9, s42, v9
v_add_u32 v10, s42, v10
v_add_u32 v11, s42, v11
s_barrier
ds_read_b64_tr_b16 v[24:25], v8 offset:0
ds_read_b64_tr_b16 v[26:27], v8 offset:3072
ds_read_b64_tr_b16 v[28:29], v9 offset:0
v_mfma_f32_32x32x16_bf16 v[64:79], v[44:47], v[56:59], v[64:79]
ds_read_b64_tr_b16 v[30:31], v9 offset:3072
ds_read_b64_tr_b16 v[32:33], v10 offset:0
v_mfma_f32_32x32x16_bf16 v[80:95], v[44:47], v[60:63], v[80:95]
ds_read_b64_tr_b16 v[34:35], v10 offset:3072
ds_read_b128 v[36:39], v11 offset:0
v_mfma_f32_32x32x16_bf16 v[96:111], v[48:51], v[56:59], v[96:111]
ds_read_b128 v[40:43], v11 offset:4096
v_mfma_f32_32x32x16_bf16 v[112:127], v[48:51], v[60:63], v[112:127]
v_mfma_f32_32x32x16_bf16 v[128:143], v[52:55], v[56:59], v[128:143]
v_mfma_f32_32x32x16_bf16 v[144:159], v[52:55], v[60:63], v[144:159]
s_sub_u32 s40, s40, 1
s_cmp_lg_u32 s40, 0
s_cbranch_scc1 .oproj_L3
s_waitcnt vmcnt(0) lgkmcnt(0)
s_nop 7
s_nop 7
s_lshl_b32 s4, s60, 6
s_lshl_b32 s5, s62, 2
s_add_u32 s4, s4, s5
s_add_u32 s4, s4, s57
s_mul_i32 s4, s4, 18
s_mul_i32 s5, s61, 6
s_add_u32 s4, s4, s5
s_add_u32 s4, s4, s56
s_lshl_b32 s4, s4, 11
v_lshlrev_b32 v1, 4, v0
s_add_u32 s5, s4, 0
v_cvt_pk_bf16_f32 v16, v64, v65
v_cvt_pk_bf16_f32 v17, v66, v67
v_cvt_pk_bf16_f32 v18, v68, v69
v_cvt_pk_bf16_f32 v19, v70, v71
buffer_store_dwordx4 v[16:19], v1, s[16:19], s5 offen offset:0 sc1
v_cvt_pk_bf16_f32 v20, v72, v73
v_cvt_pk_bf16_f32 v21, v74, v75
v_cvt_pk_bf16_f32 v22, v76, v77
v_cvt_pk_bf16_f32 v23, v78, v79
buffer_store_dwordx4 v[20:23], v1, s[16:19], s5 offen offset:1024 sc1
s_add_u32 s5, s4, 36864
v_cvt_pk_bf16_f32 v24, v80, v81
v_cvt_pk_bf16_f32 v25, v82, v83
v_cvt_pk_bf16_f32 v26, v84, v85
v_cvt_pk_bf16_f32 v27, v86, v87
buffer_store_dwordx4 v[24:27], v1, s[16:19], s5 offen offset:0 sc1
v_cvt_pk_bf16_f32 v28, v88, v89
v_cvt_pk_bf16_f32 v29, v90, v91
v_cvt_pk_bf16_f32 v30, v92, v93
v_cvt_pk_bf16_f32 v31, v94, v95
buffer_store_dwordx4 v[28:31], v1, s[16:19], s5 offen offset:1024 sc1
s_add_u32 s5, s4, 2048
v_cvt_pk_bf16_f32 v32, v96, v97
v_cvt_pk_bf16_f32 v33, v98, v99
v_cvt_pk_bf16_f32 v34, v100, v101
v_cvt_pk_bf16_f32 v35, v102, v103
buffer_store_dwordx4 v[32:35], v1, s[16:19], s5 offen offset:0 sc1
v_cvt_pk_bf16_f32 v36, v104, v105
v_cvt_pk_bf16_f32 v37, v106, v107
v_cvt_pk_bf16_f32 v38, v108, v109
v_cvt_pk_bf16_f32 v39, v110, v111
buffer_store_dwordx4 v[36:39], v1, s[16:19], s5 offen offset:1024 sc1
s_add_u32 s5, s4, 38912
v_cvt_pk_bf16_f32 v40, v112, v113
v_cvt_pk_bf16_f32 v41, v114, v115
v_cvt_pk_bf16_f32 v42, v116, v117
v_cvt_pk_bf16_f32 v43, v118, v119
buffer_store_dwordx4 v[40:43], v1, s[16:19], s5 offen offset:0 sc1
v_cvt_pk_bf16_f32 v44, v120, v121
v_cvt_pk_bf16_f32 v45, v122, v123
v_cvt_pk_bf16_f32 v46, v124, v125
v_cvt_pk_bf16_f32 v47, v126, v127
buffer_store_dwordx4 v[44:47], v1, s[16:19], s5 offen offset:1024 sc1
s_add_u32 s5, s4, 4096
v_cvt_pk_bf16_f32 v48, v128, v129
v_cvt_pk_bf16_f32 v49, v130, v131
v_cvt_pk_bf16_f32 v50, v132, v133
v_cvt_pk_bf16_f32 v51, v134, v135
buffer_store_dwordx4 v[48:51], v1, s[16:19], s5 offen offset:0 sc1
v_cvt_pk_bf16_f32 v52, v136, v137
v_cvt_pk_bf16_f32 v53, v138, v139
v_cvt_pk_bf16_f32 v54, v140, v141
v_cvt_pk_bf16_f32 v55, v142, v143
buffer_store_dwordx4 v[52:55], v1, s[16:19], s5 offen offset:1024 sc1
s_add_u32 s5, s4, 40960
v_cvt_pk_bf16_f32 v56, v144, v145
v_cvt_pk_bf16_f32 v57, v146, v147
v_cvt_pk_bf16_f32 v58, v148, v149
v_cvt_pk_bf16_f32 v59, v150, v151
buffer_store_dwordx4 v[56:59], v1, s[16:19], s5 offen offset:0 sc1
v_cvt_pk_bf16_f32 v60, v152, v153
v_cvt_pk_bf16_f32 v61, v154, v155
v_cvt_pk_bf16_f32 v62, v156, v157
v_cvt_pk_bf16_f32 v63, v158, v159
buffer_store_dwordx4 v[60:63], v1, s[16:19], s5 offen offset:1024 sc1
.oproj_end:
s_endpgm
.globl ln2_kernel
.p2align 8
.type ln2_kernel,@function
ln2_kernel:
s_cmp_ge_u32 s2, 256
s_cbranch_scc1 .ln2_end
s_and_b32 s4, s2, 7
s_lshr_b32 s5, s2, 5
s_lshl_b32 s5, s5, 3
s_add_u32 s4, s4, s5
s_bfe_u32 s5, s2, 0x20003
s_lshl_b32 s4, s4, 2
s_add_u32 s2, s4, s5
s_load_dwordx2 s[8:9], s[0:1], 104
s_load_dwordx2 s[12:13], s[0:1], 0
s_load_dwordx2 s[16:17], s[0:1], 104
s_load_dwordx2 s[20:21], s[0:1], 104
v_and_b32 v1, 7, v0
v_lshrrev_b32 v2, 3, v0
s_lshr_b32 s4, s2, 2
s_mul_i32 s4, s4, 36864
s_and_b32 s5, s2, 3
s_lshl_b32 s5, s5, 7
s_add_u32 s4, s4, s5
v_lshlrev_b32 v3, 9, v2
v_lshl_add_u32 v3, v1, 4, v3
v_lshrrev_b32 v4, 1, v2
v_mul_u32_u24 v5, 1152, v1
v_lshl_add_u32 v5, v4, 5, v5
v_and_b32 v4, 1, v2
v_lshl_add_u32 v5, v4, 3, v5
s_mul_i32 s6, s2, 9216
s_waitcnt lgkmcnt(0)
s_add_u32 s8, s8, 4194304
s_addc_u32 s9, s9, 0
s_mov_b32 s10, 11796480
s_mov_b32 s11, 0x20000
s_mov_b32 s14, 2359296
s_mov_b32 s15, 0x20000
s_add_u32 s16, s16, 27787264
s_addc_u32 s17, s17, 0
s_mov_b32 s18, 2359296
s_mov_b32 s19, 0x20000
s_add_u32 s20, s20, 30146560
s_addc_u32 s21, s21, 0
s_mov_b32 s22, 2359296
s_mov_b32 s23, 0x20000
buffer_load_dwordx4 v[40:43], v3, s[8:11], s4 offen
s_add_u32 s4, s4, 2359296
buffer_load_dwordx4 v[44:47], v3, s[8:11], s4 offen
s_add_u32 s4, s4, 2359296
buffer_load_dwordx4 v[48:51], v3, s[8:11], s4 offen
s_add_u32 s4, s4, 2359296
buffer_load_dwordx4 v[52:55], v3, s[8:11], s4 offen
s_add_u32 s4, s4, 2359296
buffer_load_dwordx4 v[56:59], v3, s[8:11], s4 offen
s_add_u32 s4, s4, 2359296
buffer_load_dwordx2 v[8:9], v5, s[12:15], s6 offen
buffer_load_dwordx2 v[10:11], v5, s[12:15], s6 offen offset:16
s_waitcnt vmcnt(6)
v_lshlrev_b32 v16, 16, v40
v_and_b32 v17, 0xffff0000, v40
v_lshlrev_b32 v18, 16, v41
v_and_b32 v19, 0xffff0000, v41
v_lshlrev_b32 v20, 16, v42
v_and_b32 v21, 0xffff0000, v42
v_lshlrev_b32 v22, 16, v43
v_and_b32 v23, 0xffff0000, v43
s_waitcnt vmcnt(5)
v_lshlrev_b32 v24, 16, v44
v_and_b32 v25, 0xffff0000, v44
v_lshlrev_b32 v26, 16, v45
v_and_b32 v27, 0xffff0000, v45
v_lshlrev_b32 v28, 16, v46
v_and_b32 v29, 0xffff0000, v46
v_lshlrev_b32 v30, 16, v47
v_and_b32 v31, 0xffff0000, v47
v_add_f32 v16, v16, v24
v_add_f32 v17, v17, v25
v_add_f32 v18, v18, v26
v_add_f32 v19, v19, v27
v_add_f32 v20, v20, v28
v_add_f32 v21, v21, v29
v_add_f32 v22, v22, v30
v_add_f32 v23, v23, v31
s_waitcnt vmcnt(4)
v_lshlrev_b32 v24, 16, v48
v_and_b32 v25, 0xffff0000, v48
v_lshlrev_b32 v26, 16, v49
v_and_b32 v27, 0xffff0000, v49
v_lshlrev_b32 v28, 16, v50
v_and_b32 v29, 0xffff0000, v50
v_lshlrev_b32 v30, 16, v51
v_and_b32 v31, 0xffff0000, v51
v_add_f32 v16, v16, v24
v_add_f32 v17, v17, v25
v_add_f32 v18, v18, v26
v_add_f32 v19, v19, v27
v_add_f32 v20, v20, v28
v_add_f32 v21, v21, v29
v_add_f32 v22, v22, v30
v_add_f32 v23, v23, v31
s_waitcnt vmcnt(3)
v_lshlrev_b32 v24, 16, v52
v_and_b32 v25, 0xffff0000, v52
v_lshlrev_b32 v26, 16, v53
v_and_b32 v27, 0xffff0000, v53
v_lshlrev_b32 v28, 16, v54
v_and_b32 v29, 0xffff0000, v54
v_lshlrev_b32 v30, 16, v55
v_and_b32 v31, 0xffff0000, v55
v_add_f32 v16, v16, v24
v_add_f32 v17, v17, v25
v_add_f32 v18, v18, v26
v_add_f32 v19, v19, v27
v_add_f32 v20, v20, v28
v_add_f32 v21, v21, v29
v_add_f32 v22, v22, v30
v_add_f32 v23, v23, v31
s_waitcnt vmcnt(2)
v_lshlrev_b32 v24, 16, v56
v_and_b32 v25, 0xffff0000, v56
v_lshlrev_b32 v26, 16, v57
v_and_b32 v27, 0xffff0000, v57
v_lshlrev_b32 v28, 16, v58
v_and_b32 v29, 0xffff0000, v58
v_lshlrev_b32 v30, 16, v59
v_and_b32 v31, 0xffff0000, v59
v_add_f32 v16, v16, v24
v_add_f32 v17, v17, v25
v_add_f32 v18, v18, v26
v_add_f32 v19, v19, v27
v_add_f32 v20, v20, v28
v_add_f32 v21, v21, v29
v_add_f32 v22, v22, v30
v_add_f32 v23, v23, v31
s_waitcnt vmcnt(0)
v_cvt_pk_bf16_f32 v24, v16, v17
v_cvt_pk_bf16_f32 v25, v18, v19
v_cvt_pk_bf16_f32 v26, v20, v21
v_cvt_pk_bf16_f32 v27, v22, v23
v_lshlrev_b32 v16, 16, v24
v_and_b32 v17, 0xffff0000, v24
v_lshlrev_b32 v18, 16, v25
v_and_b32 v19, 0xffff0000, v25
v_lshlrev_b32 v20, 16, v26
v_and_b32 v21, 0xffff0000, v26
v_lshlrev_b32 v22, 16, v27
v_and_b32 v23, 0xffff0000, v27
v_lshlrev_b32 v32, 16, v8
v_and_b32 v33, 0xffff0000, v8
v_lshlrev_b32 v34, 16, v9
v_and_b32 v35, 0xffff0000, v9
v_lshlrev_b32 v36, 16, v10
v_and_b32 v37, 0xffff0000, v10
v_lshlrev_b32 v38, 16, v11
v_and_b32 v39, 0xffff0000, v11
v_add_f32 v16, v16, v32
v_add_f32 v17, v17, v33
v_add_f32 v18, v18, v34
v_add_f32 v19, v19, v35
v_add_f32 v20, v20, v36
v_add_f32 v21, v21, v37
v_add_f32 v22, v22, v38
v_add_f32 v23, v23, v39
v_cvt_pk_bf16_f32 v24, v16, v17
v_cvt_pk_bf16_f32 v25, v18, v19
v_cvt_pk_bf16_f32 v26, v20, v21
v_cvt_pk_bf16_f32 v27, v22, v23
v_lshlrev_b32 v16, 16, v24
v_and_b32 v17, 0xffff0000, v24
v_lshlrev_b32 v18, 16, v25
v_and_b32 v19, 0xffff0000, v25
v_lshlrev_b32 v20, 16, v26
v_and_b32 v21, 0xffff0000, v26
v_lshlrev_b32 v22, 16, v27
v_and_b32 v23, 0xffff0000, v27
buffer_store_dwordx2 v[24:25], v5, s[16:19], s6 offen
buffer_store_dwordx2 v[26:27], v5, s[16:19], s6 offen offset:16
v_lshrrev_b32 v7, 6, v0
v_lshlrev_b32 v7, 5, v7
v_lshl_add_u32 v7, v1, 2, v7
v_lshlrev_b32 v6, 2, v1
v_add_f32 v12, v16, v17
v_add_f32 v12, v12, v18
v_add_f32 v12, v12, v19
v_add_f32 v12, v12, v20
v_add_f32 v12, v12, v21
v_add_f32 v12, v12, v22
v_add_f32 v12, v12, v23
s_nop 1
v_add_f32_dpp v12, v12, v12 row_ror:8 row_mask:0xf bank_mask:0xf
v_mov_b32 v13, v12
s_nop 1
v_permlane16_swap_b32 v13, v12
s_nop 1
v_add_f32 v12, v12, v13
v_mov_b32 v13, v12
s_nop 1
v_permlane32_swap_b32 v13, v12
s_nop 1
v_add_f32 v12, v12, v13
ds_write_b32 v7, v12 offset:0
s_waitcnt lgkmcnt(0)
s_barrier
ds_read_b32 v32, v6 offset:0
ds_read_b32 v33, v6 offset:32
ds_read_b32 v34, v6 offset:64
ds_read_b32 v35, v6 offset:96
ds_read_b32 v36, v6 offset:128
ds_read_b32 v37, v6 offset:160
ds_read_b32 v38, v6 offset:192
ds_read_b32 v39, v6 offset:224
ds_read_b32 v40, v6 offset:256
s_waitcnt lgkmcnt(0)
v_add_f32 v12, v32, v33
v_add_f32 v12, v12, v34
v_add_f32 v12, v12, v35
v_add_f32 v12, v12, v36
v_add_f32 v12, v12, v37
v_add_f32 v12, v12, v38
v_add_f32 v12, v12, v39
v_add_f32 v12, v12, v40
v_mul_f32 v12, 0x3ae38e39, v12
v_sub_f32 v16, v16, v12
v_sub_f32 v17, v17, v12
v_sub_f32 v18, v18, v12
v_sub_f32 v19, v19, v12
v_sub_f32 v20, v20, v12
v_sub_f32 v21, v21, v12
v_sub_f32 v22, v22, v12
v_sub_f32 v23, v23, v12
v_mul_f32 v12, v16, v16
v_fmac_f32 v12, v17, v17
v_fmac_f32 v12, v18, v18
v_fmac_f32 v12, v19, v19
v_fmac_f32 v12, v20, v20
v_fmac_f32 v12, v21, v21
v_fmac_f32 v12, v22, v22
v_fmac_f32 v12, v23, v23
s_nop 1
v_add_f32_dpp v12, v12, v12 row_ror:8 row_mask:0xf bank_mask:0xf
v_mov_b32 v13, v12
s_nop 1
v_permlane16_swap_b32 v13, v12
s_nop 1
v_add_f32 v12, v12, v13
v_mov_b32 v13, v12
s_nop 1
v_permlane32_swap_b32 v13, v12
s_nop 1
v_add_f32 v12, v12, v13
ds_write_b32 v7, v12 offset:512
s_waitcnt lgkmcnt(0)
s_barrier
ds_read_b32 v32, v6 offset:512
ds_read_b32 v33, v6 offset:544
ds_read_b32 v34, v6 offset:576
ds_read_b32 v35, v6 offset:608
ds_read_b32 v36, v6 offset:640
ds_read_b32 v37, v6 offset:672
ds_read_b32 v38, v6 offset:704
ds_read_b32 v39, v6 offset:736
ds_read_b32 v40, v6 offset:768
s_waitcnt lgkmcnt(0)
v_add_f32 v12, v32, v33
v_add_f32 v12, v12, v34
v_add_f32 v12, v12, v35
v_add_f32 v12, v12, v36
v_add_f32 v12, v12, v37
v_add_f32 v12, v12, v38
v_add_f32 v12, v12, v39
v_add_f32 v12, v12, v40
v_mov_b32 v13, 0x3727c5ac
v_fmac_f32 v13, 0x3ae38e39, v12
v_rsq_f32 v12, v13
s_nop 0
v_mul_f32 v13, v13, v12
v_mul_f32 v13, v13, v12
v_fma_f32 v13, v13, -0.5, 1.0
v_add_f32 v13, 0.5, v13
v_mul_f32 v12, v12, v13
v_mul_f32 v16, v12, v16
v_mul_f32 v17, v12, v17
v_mul_f32 v18, v12, v18
v_mul_f32 v19, v12, v19
v_mul_f32 v20, v12, v20
v_mul_f32 v21, v12, v21
v_mul_f32 v22, v12, v22
v_mul_f32 v23, v12, v23
v_cvt_pk_bf16_f32 v24, v16, v17
v_cvt_pk_bf16_f32 v25, v18, v19
v_cvt_pk_bf16_f32 v26, v20, v21
v_cvt_pk_bf16_f32 v27, v22, v23
v_lshlrev_b32 v16, 16, v24
v_and_b32 v17, 0xffff0000, v24
v_lshlrev_b32 v18, 16, v25
v_and_b32 v19, 0xffff0000, v25
v_lshlrev_b32 v20, 16, v26
v_and_b32 v21, 0xffff0000, v26
v_lshlrev_b32 v22, 16, v27
v_and_b32 v23, 0xffff0000, v27
v_add_f32 v12, v16, v17
v_add_f32 v12, v12, v18
v_add_f32 v12, v12, v19
v_add_f32 v12, v12, v20
v_add_f32 v12, v12, v21
v_add_f32 v12, v12, v22
v_add_f32 v12, v12, v23
s_nop 1
v_add_f32_dpp v12, v12, v12 row_ror:8 row_mask:0xf bank_mask:0xf
v_mov_b32 v13, v12
s_nop 1
v_permlane16_swap_b32 v13, v12
s_nop 1
v_add_f32 v12, v12, v13
v_mov_b32 v13, v12
s_nop 1
v_permlane32_swap_b32 v13, v12
s_nop 1
v_add_f32 v12, v12, v13
ds_write_b32 v7, v12 offset:1024
s_waitcnt lgkmcnt(0)
s_barrier
ds_read_b32 v32, v6 offset:1024
ds_read_b32 v33, v6 offset:1056
ds_read_b32 v34, v6 offset:1088
ds_read_b32 v35, v6 offset:1120
ds_read_b32 v36, v6 offset:1152
ds_read_b32 v37, v6 offset:1184
ds_read_b32 v38, v6 offset:1216
ds_read_b32 v39, v6 offset:1248
ds_read_b32 v40, v6 offset:1280
s_waitcnt lgkmcnt(0)
v_add_f32 v12, v32, v33
v_add_f32 v12, v12, v34
v_add_f32 v12, v12, v35
v_add_f32 v12, v12, v36
v_add_f32 v12, v12, v37
v_add_f32 v12, v12, v38
v_add_f32 v12, v12, v39
v_add_f32 v12, v12, v40
v_mul_f32 v12, 0x3ae38e39, v12
v_sub_f32 v16, v16, v12
v_sub_f32 v17, v17, v12
v_sub_f32 v18, v18, v12
v_sub_f32 v19, v19, v12
v_sub_f32 v20, v20, v12
v_sub_f32 v21, v21, v12
v_sub_f32 v22, v22, v12
v_sub_f32 v23, v23, v12
v_mul_f32 v12, v16, v16
v_fmac_f32 v12, v17, v17
v_fmac_f32 v12, v18, v18
v_fmac_f32 v12, v19, v19
v_fmac_f32 v12, v20, v20
v_fmac_f32 v12, v21, v21
v_fmac_f32 v12, v22, v22
v_fmac_f32 v12, v23, v23
s_nop 1
v_add_f32_dpp v12, v12, v12 row_ror:8 row_mask:0xf bank_mask:0xf
v_mov_b32 v13, v12
s_nop 1
v_permlane16_swap_b32 v13, v12
s_nop 1
v_add_f32 v12, v12, v13
v_mov_b32 v13, v12
s_nop 1
v_permlane32_swap_b32 v13, v12
s_nop 1
v_add_f32 v12, v12, v13
ds_write_b32 v7, v12 offset:1536
s_waitcnt lgkmcnt(0)
s_barrier
ds_read_b32 v32, v6 offset:1536
ds_read_b32 v33, v6 offset:1568
ds_read_b32 v34, v6 offset:1600
ds_read_b32 v35, v6 offset:1632
ds_read_b32 v36, v6 offset:1664
ds_read_b32 v37, v6 offset:1696
ds_read_b32 v38, v6 offset:1728
ds_read_b32 v39, v6 offset:1760
ds_read_b32 v40, v6 offset:1792
s_waitcnt lgkmcnt(0)
v_add_f32 v12, v32, v33
v_add_f32 v12, v12, v34
v_add_f32 v12, v12, v35
v_add_f32 v12, v12, v36
v_add_f32 v12, v12, v37
v_add_f32 v12, v12, v38
v_add_f32 v12, v12, v39
v_add_f32 v12, v12, v40
v_mov_b32 v13, 0x3727c5ac
v_fmac_f32 v13, 0x3ae38e39, v12
v_rsq_f32 v12, v13
s_nop 0
v_mul_f32 v13, v13, v12
v_mul_f32 v13, v13, v12
v_fma_f32 v13, v13, -0.5, 1.0
v_add_f32 v13, 0.5, v13
v_mul_f32 v12, v12, v13
v_mul_f32 v16, v12, v16
v_mul_f32 v17, v12, v17
v_mul_f32 v18, v12, v18
v_mul_f32 v19, v12, v19
v_mul_f32 v20, v12, v20
v_mul_f32 v21, v12, v21
v_mul_f32 v22, v12, v22
v_mul_f32 v23, v12, v23
v_cvt_pk_bf16_f32 v24, v16, v17
v_cvt_pk_bf16_f32 v25, v18, v19
v_cvt_pk_bf16_f32 v26, v20, v21
v_cvt_pk_bf16_f32 v27, v22, v23
v_lshlrev_b32 v16, 16, v24
v_and_b32 v17, 0xffff0000, v24
v_lshlrev_b32 v18, 16, v25
v_and_b32 v19, 0xffff0000, v25
v_lshlrev_b32 v20, 16, v26
v_and_b32 v21, 0xffff0000, v26
v_lshlrev_b32 v22, 16, v27
v_and_b32 v23, 0xffff0000, v27
v_lshrrev_b32 v4, 1, v2
v_mul_u32_u24 v6, 43, v4
v_lshrrev_b32 v6, 8, v6
v_mul_u32_u24 v7, 6, v6
v_sub_u32 v4, v4, v7
v_mul_u32_u24 v6, 393216, v6
v_lshl_add_u32 v6, v4, 5, v6
v_and_b32 v4, 1, v2
v_lshl_add_u32 v6, v4, 3, v6
v_mul_u32_u24 v5, 192, v1
v_add_u32 v5, v5, v6
s_mul_i32 s6, s2, 1536
buffer_store_dwordx2 v[24:25], v5, s[20:23], s6 offen
buffer_store_dwordx2 v[26:27], v5, s[20:23], s6 offen offset:16
.ln2_end:
s_endpgm
.globl mlp1_kernel
.p2align 8
.type mlp1_kernel,@function
mlp1_kernel:
s_cmp_ge_u32 s2, 256
s_cbranch_scc1 .mlp1_end
v_readfirstlane_b32 s3, v0
v_and_b32 v0, 63, v0
s_lshr_b32 s3, s3, 6
s_cmp_lt_u32 s2, 216
s_cbranch_scc1 .mlp1_go
s_load_dwordx2 s[8:9], s[0:1], 72
s_load_dwordx2 s[12:13], s[0:1], 88
s_waitcnt lgkmcnt(0)
s_mov_b32 s10, 18874368
s_mov_b32 s11, 0x20000
s_mov_b32 s14, 2359296
s_mov_b32 s15, 0x20000
s_sub_u32 s4, s2, 216
s_lshl_b32 s4, s4, 3
s_add_u32 s4, s4, s3
s_lshl_b32 s4, s4, 13
v_lshl_add_u32 v1, v0, 7, s4
buffer_load_dword v2, v1, s[12:15], 0 offen
buffer_load_dword v2, v1, s[8:11], 0 offen
v_add_u32 v1, 2621440, v1
s_waitcnt vmcnt(1)
buffer_load_dword v2, v1, s[8:11], 0 offen
v_add_u32 v1, 2621440, v1
s_waitcnt vmcnt(1)
buffer_load_dword v2, v1, s[8:11], 0 offen
v_add_u32 v1, 2621440, v1
s_waitcnt vmcnt(1)
buffer_load_dword v2, v1, s[8:11], 0 offen
v_add_u32 v1, 2621440, v1
s_waitcnt vmcnt(1)
buffer_load_dword v2, v1, s[8:11], 0 offen
v_add_u32 v1, 2621440, v1
s_waitcnt vmcnt(1)
buffer_load_dword v2, v1, s[8:11], 0 offen
v_add_u32 v1, 2621440, v1
s_waitcnt vmcnt(1)
buffer_load_dword v2, v1, s[8:11], 0 offen
v_add_u32 v1, 2621440, v1
s_waitcnt vmcnt(1)
buffer_load_dword v2, v1, s[8:11], 0 offen
v_add_u32 v1, 2621440, v1
s_waitcnt vmcnt(1)
s_waitcnt vmcnt(0)
s_endpgm
.mlp1_go:
s_load_dwordx2 s[8:9], s[0:1], 56
s_load_dwordx2 s[12:13], s[0:1], 104
s_load_dwordx2 s[16:17], s[0:1], 104
s_load_dwordx2 s[20:21], s[0:1], 64
s_and_b32 s4, s2, 7
s_mul_i32 s4, s4, 27
s_lshr_b32 s5, s2, 3
s_add_u32 s4, s4, s5
s_mul_i32 s60, s4, 171
s_lshr_b32 s60, s60, 10
s_mul_i32 s5, s60, 6
s_sub_u32 s61, s4, s5
s_lshl_b32 s50, s60, 8
s_mul_i32 s51, s61, 393216
s_and_b32 s56, s3, 1
s_lshl_b32 s56, s56, 1
s_mov_b32 s57, 0
s_bfe_u32 s62, s3, 0x10001
s_lshl_b32 s58, s62, 13
s_mul_i32 s59, s62, 6144
s_and_b32 s68, s60, 3
s_lshl_b32 s63, s60, 2
s_add_u32 s63, s63, s56
s_add_u32 s63, s63, s62
s_cmp_lt_u32 s3, 4
s_cbranch_scc1 .mlp1_L1
s_sub_u32 s3, s3, 4
s_mul_i32 s4, s3, 4
s_add_u32 s4, s4, 0
s_lshl_b32 s4, s4, 6
v_add_u32 v1, s4, v0
v_mul_u32_u24 v2, 4096, v1
v_lshrrev_b32 v2, 16, v2
v_mul_u32_u24 v3, 16, v2
v_sub_u32 v3, v1, v3
v_and_b32 v4, 3, v2
v_lshlrev_b32 v4, 2, v4
v_xor_b32 v3, v3, v4
v_mul_u32_u24 v2, 9216, v2
v_lshl_add_u32 v8, v3, 4, v2
s_mul_i32 s4, s3, 4
s_add_u32 s4, s4, 1
s_lshl_b32 s4, s4, 6
v_add_u32 v1, s4, v0
v_mul_u32_u24 v2, 4096, v1
v_lshrrev_b32 v2, 16, v2
v_mul_u32_u24 v3, 16, v2
v_sub_u32 v3, v1, v3
v_and_b32 v4, 3, v2
v_lshlrev_b32 v4, 2, v4
v_xor_b32 v3, v3, v4
v_mul_u32_u24 v2, 9216, v2
v_lshl_add_u32 v9, v3, 4, v2
s_mul_i32 s4, s3, 4
s_add_u32 s4, s4, 2
s_lshl_b32 s4, s4, 6
v_add_u32 v1, s4, v0
v_mul_u32_u24 v2, 4096, v1
v_lshrrev_b32 v2, 16, v2
v_mul_u32_u24 v3, 16, v2
v_sub_u32 v3, v1, v3
v_and_b32 v4, 3, v2
v_lshlrev_b32 v4, 2, v4
v_xor_b32 v3, v3, v4
v_mul_u32_u24 v2, 9216, v2
v_lshl_add_u32 v10, v3, 4, v2
s_mul_i32 s4, s3, 4
s_add_u32 s4, s4, 3
s_lshl_b32 s4, s4, 6
v_add_u32 v1, s4, v0
v_mul_u32_u24 v2, 4096, v1
v_lshrrev_b32 v2, 16, v2
v_mul_u32_u24 v3, 16, v2
v_sub_u32 v3, v1, v3
v_and_b32 v4, 3, v2
v_lshlrev_b32 v4, 2, v4
v_xor_b32 v3, v3, v4
v_mul_u32_u24 v2, 9216, v2
v_lshl_add_u32 v11, v3, 4, v2
s_mul_i32 s53, s3, 4096
s_add_u32 s53, s53, 0
s_mul_i32 s4, s3, 3
s_add_u32 s4, s4, 0
s_lshl_b32 s4, s4, 6
v_add_u32 v1, s4, v0
v_mul_u32_u24 v2, 5462, v1
v_lshrrev_b32 v2, 16, v2
v_mul_u32_u24 v3, 12, v2
v_sub_u32 v3, v1, v3
v_mul_u32_u24 v2, 192, v2
v_lshl_add_u32 v12, v3, 4, v2
s_mul_i32 s4, s3, 3
s_add_u32 s4, s4, 1
s_lshl_b32 s4, s4, 6
v_add_u32 v1, s4, v0
v_mul_u32_u24 v2, 5462, v1
v_lshrrev_b32 v2, 16, v2
v_mul_u32_u24 v3, 12, v2
v_sub_u32 v3, v1, v3
v_mul_u32_u24 v2, 192, v2
v_lshl_add_u32 v13, v3, 4, v2
s_mul_i32 s4, s3, 3
s_add_u32 s4, s4, 2
s_lshl_b32 s4, s4, 6
v_add_u32 v1, s4, v0
v_mul_u32_u24 v2, 5462, v1
v_lshrrev_b32 v2, 16, v2
v_mul_u32_u24 v3, 12, v2
v_sub_u32 v3, v1, v3
v_mul_u32_u24 v2, 192, v2
v_lshl_add_u32 v14, v3, 4, v2
s_mul_i32 s54, s3, 3072
s_add_u32 s54, s54, 16384
s_waitcnt lgkmcnt(0)
s_mov_b32 s10, 18874368
s_mov_b32 s11, 0x20000
s_add_u32 s12, s12, 30146560
s_addc_u32 s13, s13, 0
s_mov_b32 s14, 2359296
s_mov_b32 s15, 0x20000
s_add_u32 s16, s16, 32505856
s_addc_u32 s17, s17, 0
s_mov_b32 s18, 5308416
s_mov_b32 s19, 0x20000
s_mov_b32 s22, 9216
s_mov_b32 s23, 0x20000
s_mov_b32 s40, 32
s_mov_b32 s44, 32
s_mov_b32 s41, 0
s_mov_b32 s43, 0
s_mov_b32 s45, 28672
s_cmp_gt_i32 s44, 0
s_cselect_b32 s10, s10, 0
s_cselect_b32 s14, s14, 0
s_sub_u32 s44, s44, 1
s_add_u32 m0, s41, s53
s_nop 0
buffer_load_dwordx4 v8, s[8:11], s50 offen lds
s_add_u32 m0, m0, 1024
s_nop 0
buffer_load_dwordx4 v9, s[8:11], s50 offen lds
s_add_u32 m0, m0, 1024
s_nop 0
buffer_load_dwordx4 v10, s[8:11], s50 offen lds
s_add_u32 m0, m0, 1024
s_nop 0
buffer_load_dwordx4 v11, s[8:11], s50 offen lds
s_add_u32 s50, s50, 589824
s_add_u32 m0, s41, s54
s_nop 0
buffer_load_dwordx4 v12, s[12:15], s51 offen lds
s_add_u32 m0, m0, 1024
s_nop 0
buffer_load_dwordx4 v13, s[12:15], s51 offen lds
s_add_u32 m0, m0, 1024
s_nop 0
buffer_load_dwordx4 v14, s[12:15], s51 offen lds
s_add_u32 s51, s51, 12288
s_add_u32 s41, s41, 28672
s_cmp_eq_u32 s41, 143360
s_cselect_b32 s41, 0, s41
s_cmp_gt_i32 s44, 0
s_cselect_b32 s10, s10, 0
s_cselect_b32 s14, s14, 0
s_sub_u32 s44, s44, 1
s_add_u32 m0, s41, s53
s_nop 0
buffer_load_dwordx4 v8, s[8:11], s50 offen lds
s_add_u32 m0, m0, 1024
s_nop 0
buffer_load_dwordx4 v9, s[8:11], s50 offen lds
s_add_u32 m0, m0, 1024
s_nop 0
buffer_load_dwordx4 v10, s[8:11], s50 offen lds
s_add_u32 m0, m0, 1024
s_nop 0
buffer_load_dwordx4 v11, s[8:11], s50 offen lds
s_add_u32 s50, s50, 589824
s_add_u32 m0, s41, s54
s_nop 0
buffer_load_dwordx4 v12, s[12:15], s51 offen lds
s_add_u32 m0, m0, 1024
s_nop 0
buffer_load_dwordx4 v13, s[12:15], s51 offen lds
s_add_u32 m0, m0, 1024
s_nop 0
buffer_load_dwordx4 v14, s[12:15], s51 offen lds
s_add_u32 s51, s51, 12288
s_add_u32 s41, s41, 28672
s_cmp_eq_u32 s41, 143360
s_cselect_b32 s41, 0, s41
s_cmp_gt_i32 s44, 0
s_cselect_b32 s10, s10, 0
s_cselect_b32 s14, s14, 0
s_sub_u32 s44, s44, 1
s_add_u32 m0, s41, s53
s_nop 0
buffer_load_dwordx4 v8, s[8:11], s50 offen lds
s_add_u32 m0, m0, 1024
s_nop 0
buffer_load_dwordx4 v9, s[8:11], s50 offen lds
s_add_u32 m0, m0, 1024
s_nop 0
buffer_load_dwordx4 v10, s[8:11], s50 offen lds
s_add_u32 m0, m0, 1024
s_nop 0
buffer_load_dwordx4 v11, s[8:11], s50 offen lds
s_add_u32 s50, s50, 589824
s_add_u32 m0, s41, s54
s_nop 0
buffer_load_dwordx4 v12, s[12:15], s51 offen lds
s_add_u32 m0, m0, 1024
s_nop 0
buffer_load_dwordx4 v13, s[12:15], s51 offen lds
s_add_u32 m0, m0, 1024
s_nop 0
buffer_load_dwordx4 v14, s[12:15], s51 offen lds
s_add_u32 s51, s51, 12288
s_add_u32 s41, s41, 28672
s_cmp_eq_u32 s41, 143360
s_cselect_b32 s41, 0, s41
s_cmp_gt_i32 s44, 0
s_cselect_b32 s10, s10, 0
s_cselect_b32 s14, s14, 0
s_sub_u32 s44, s44, 1
s_add_u32 m0, s41, s53
s_nop 0
buffer_load_dwordx4 v8, s[8:11], s50 offen lds
s_add_u32 m0, m0, 1024
s_nop 0
buffer_load_dwordx4 v9, s[8:11], s50 offen lds
s_add_u32 m0, m0, 1024
s_nop 0
buffer_load_dwordx4 v10, s[8:11], s50 offen lds
s_add_u32 m0, m0, 1024
s_nop 0
buffer_load_dwordx4 v11, s[8:11], s50 offen lds
s_add_u32 s50, s50, 589824
s_add_u32 m0, s41, s54
s_nop 0
buffer_load_dwordx4 v12, s[12:15], s51 offen lds
s_add_u32 m0, m0, 1024
s_nop 0
buffer_load_dwordx4 v13, s[12:15], s51 offen lds
s_add_u32 m0, m0, 1024
s_nop 0
buffer_load_dwordx4 v14, s[12:15], s51 offen lds
s_add_u32 s51, s51, 12288
s_add_u32 s41, s41, 28672
s_cmp_eq_u32 s41, 143360
s_cselect_b32 s41, 0, s41
s_cmp_gt_i32 s44, 0
s_cselect_b32 s10, s10, 0
s_cselect_b32 s14, s14, 0
s_sub_u32 s44, s44, 1
s_add_u32 m0, s41, s53
s_nop 0
buffer_load_dwordx4 v8, s[8:11], s50 offen lds
s_add_u32 m0, m0, 1024
s_nop 0
buffer_load_dwordx4 v9, s[8:11], s50 offen lds
s_add_u32 m0, m0, 1024
s_nop 0
buffer_load_dwordx4 v10, s[8:11], s50 offen lds
s_add_u32 m0, m0, 1024
s_nop 0
buffer_load_dwordx4 v11, s[8:11], s50 offen lds
s_add_u32 s50, s50, 589824
s_add_u32 m0, s41, s54
s_nop 0
buffer_load_dwordx4 v12, s[12:15], s51 offen lds
s_add_u32 m0, m0, 1024
s_nop 0
buffer_load_dwordx4 v13, s[12:15], s51 offen lds
s_add_u32 m0, m0, 1024
s_nop 0
buffer_load_dwordx4 v14, s[12:15], s51 offen lds
s_add_u32 s51, s51, 12288
s_add_u32 s41, s41, 28672
s_cmp_eq_u32 s41, 143360
s_cselect_b32 s41, 0, s41
s_waitcnt vmcnt(28)
s_barrier
.mlp1_L2:
s_waitcnt vmcnt(21)
s_barrier
s_cmp_gt_i32 s44, 0
s_cselect_b32 s10, s10, 0
s_cselect_b32 s14, s14, 0
s_sub_u32 s44, s44, 1
s_add_u32 m0, s41, s53
s_nop 0
buffer_load_dwordx4 v8, s[8:11], s50 offen lds
s_add_u32 m0, m0, 1024
s_nop 0
buffer_load_dwordx4 v9, s[8:11], s50 offen lds
s_add_u32 m0, m0, 1024
s_nop 0
buffer_load_dwordx4 v10, s[8:11], s50 offen lds
s_add_u32 m0, m0, 1024
s_nop 0
buffer_load_dwordx4 v11, s[8:11], s50 offen lds
s_add_u32 s50, s50, 589824
s_add_u32 m0, s41, s54
s_nop 0
buffer_load_dwordx4 v12, s[12:15], s51 offen lds
s_add_u32 m0, m0, 1024
s_nop 0
buffer_load_dwordx4 v13, s[12:15], s51 offen lds
s_add_u32 m0, m0, 1024
s_nop 0
buffer_load_dwordx4 v14, s[12:15], s51 offen lds
s_add_u32 s51, s51, 12288
s_add_u32 s41, s41, 28672
s_cmp_eq_u32 s41, 143360
s_cselect_b32 s41, 0, s41
s_sub_u32 s40, s40, 1
s_cmp_lg_u32 s40, 0
s_cbranch_scc1 .mlp1_L2
s_waitcnt vmcnt(0) lgkmcnt(0)
s_nop 7
s_nop 7
s_endpgm
.mlp1_L1:
v_bfe_u32 v1, v0, 2, 2
v_lshrrev_b32 v2, 5, v0
v_lshl_add_u32 v2, v2, 3, v1
v_mul_u32_u24 v2, 256, v2
v_bfe_u32 v3, v0, 4, 1
v_lshl_add_u32 v2, v3, 5, v2
v_and_b32 v3, 3, v0
v_lshl_add_u32 v2, v3, 3, v2
v_add_u32 v2, 0, v2
s_add_u32 s4, s56, 0
v_xor_b32 v3, s4, v1
v_lshl_add_u32 v8, v3, 6, v2
s_add_u32 s4, s56, 1
v_xor_b32 v3, s4, v1
v_lshl_add_u32 v9, v3, 6, v2
v_add_u32 v8, s58, v8
v_add_u32 v9, s58, v9
v_bfe_u32 v1, v0, 2, 2
v_lshrrev_b32 v2, 5, v0
v_lshl_add_u32 v2, v2, 3, v1
v_mul_u32_u24 v2, 192, v2
v_bfe_u32 v3, v0, 4, 1
v_lshl_add_u32 v2, v3, 5, v2
v_and_b32 v3, 3, v0
v_lshl_add_u32 v2, v3, 3, v2
v_add_u32 v2, 16384, v2
v_mov_b32 v1, 0
s_add_u32 s4, s57, 0
v_xor_b32 v3, s4, v1
v_lshl_add_u32 v10, v3, 6, v2
s_add_u32 s4, s57, 1
v_xor_b32 v3, s4, v1
v_lshl_add_u32 v11, v3, 6, v2
s_add_u32 s4, s57, 2
v_xor_b32 v3, s4, v1
v_lshl_add_u32 v12, v3, 6, v2
v_add_u32 v10, s59, v10
v_add_u32 v11, s59, v11
v_add_u32 v12, s59, v12
s_waitcnt lgkmcnt(0)
s_mov_b32 s10, 18874368
s_mov_b32 s11, 0x20000
s_add_u32 s12, s12, 30146560
s_addc_u32 s13, s13, 0
s_mov_b32 s14, 2359296
s_mov_b32 s15, 0x20000
s_add_u32 s16, s16, 32505856
s_addc_u32 s17, s17, 0
s_mov_b32 s18, 5308416
s_mov_b32 s19, 0x20000
s_mov_b32 s22, 9216
s_mov_b32 s23, 0x20000
s_lshl_b32 s4, s63, 6
v_lshrrev_b32 v1, 5, v0
v_lshlrev_b32 v1, 3, v1
buffer_load_dwordx2 v[160:161], v1, s[20:23], s4 offen offset:0
buffer_load_dwordx2 v[162:163], v1, s[20:23], s4 offen offset:16
buffer_load_dwordx2 v[164:165], v1, s[20:23], s4 offen offset:32
buffer_load_dwordx2 v[166:167], v1, s[20:23], s4 offen offset:48
s_mov_b32 s40, 32
s_mov_b32 s44, 32
s_mov_b32 s41, 0
s_mov_b32 s43, 0
s_mov_b32 s45, 28672
v_mov_b32 v64, 0
v_mov_b32 v65, 0
v_mov_b32 v66, 0
v_mov_b32 v67, 0
v_mov_b32 v68, 0
v_mov_b32 v69, 0
v_mov_b32 v70, 0
v_mov_b32 v71, 0
v_mov_b32 v72, 0
v_mov_b32 v73, 0
v_mov_b32 v74, 0
v_mov_b32 v75, 0
v_mov_b32 v76, 0
v_mov_b32 v77, 0
v_mov_b32 v78, 0
v_mov_b32 v79, 0
v_mov_b32 v80, 0
v_mov_b32 v81, 0
v_mov_b32 v82, 0
v_mov_b32 v83, 0
v_mov_b32 v84, 0
v_mov_b32 v85, 0
v_mov_b32 v86, 0
v_mov_b32 v87, 0
v_mov_b32 v88, 0
v_mov_b32 v89, 0
v_mov_b32 v90, 0
v_mov_b32 v91, 0
v_mov_b32 v92, 0
v_mov_b32 v93, 0
v_mov_b32 v94, 0
v_mov_b32 v95, 0
v_mov_b32 v96, 0
v_mov_b32 v97, 0
v_mov_b32 v98, 0
v_mov_b32 v99, 0
v_mov_b32 v100, 0
v_mov_b32 v101, 0
v_mov_b32 v102, 0
v_mov_b32 v103, 0
v_mov_b32 v104, 0
v_mov_b32 v105, 0
v_mov_b32 v106, 0
v_mov_b32 v107, 0
v_mov_b32 v108, 0
v_mov_b32 v109, 0
v_mov_b32 v110, 0
v_mov_b32 v111, 0
v_mov_b32 v112, 0
v_mov_b32 v113, 0
v_mov_b32 v114, 0
v_mov_b32 v115, 0
v_mov_b32 v116, 0
v_mov_b32 v117, 0
v_mov_b32 v118, 0
v_mov_b32 v119, 0
v_mov_b32 v120, 0
v_mov_b32 v121, 0
v_mov_b32 v122, 0
v_mov_b32 v123, 0
v_mov_b32 v124, 0
v_mov_b32 v125, 0
v_mov_b32 v126, 0
v_mov_b32 v127, 0
v_mov_b32 v128, 0
v_mov_b32 v129, 0
v_mov_b32 v130, 0
v_mov_b32 v131, 0
v_mov_b32 v132, 0
v_mov_b32 v133, 0
v_mov_b32 v134, 0
v_mov_b32 v135, 0
v_mov_b32 v136, 0
v_mov_b32 v137, 0
v_mov_b32 v138, 0
v_mov_b32 v139, 0
v_mov_b32 v140, 0
v_mov_b32 v141, 0
v_mov_b32 v142, 0
v_mov_b32 v143, 0
v_mov_b32 v144, 0
v_mov_b32 v145, 0
v_mov_b32 v146, 0
v_mov_b32 v147, 0
v_mov_b32 v148, 0
v_mov_b32 v149, 0
v_mov_b32 v150, 0
v_mov_b32 v151, 0
v_mov_b32 v152, 0
v_mov_b32 v153, 0
v_mov_b32 v154, 0
v_mov_b32 v155, 0
v_mov_b32 v156, 0
v_mov_b32 v157, 0
v_mov_b32 v158, 0
v_mov_b32 v159, 0
s_barrier
ds_read_b64_tr_b16 v[24:25], v8 offset:0
ds_read_b64_tr_b16 v[26:27], v8 offset:1024
ds_read_b64_tr_b16 v[28:29], v9 offset:0
ds_read_b64_tr_b16 v[30:31], v9 offset:1024
ds_read_b64_tr_b16 v[32:33], v10 offset:0
ds_read_b64_tr_b16 v[34:35], v10 offset:768
ds_read_b64_tr_b16 v[36:37], v11 offset:0
ds_read_b64_tr_b16 v[38:39], v11 offset:768
ds_read_b64_tr_b16 v[40:41], v12 offset:0
ds_read_b64_tr_b16 v[42:43], v12 offset:768
.mlp1_L3:
ds_read_b64_tr_b16 v[44:45], v8 offset:4096
ds_read_b64_tr_b16 v[46:47], v8 offset:5120
ds_read_b64_tr_b16 v[48:49], v9 offset:4096
s_waitcnt lgkmcnt(3)
v_mfma_f32_32x32x16_bf16 v[64:79], v[24:27], v[32:35], v[64:79]
ds_read_b64_tr_b16 v[50:51], v9 offset:5120
ds_read_b64_tr_b16 v[52:53], v10 offset:3072
v_mfma_f32_32x32x16_bf16 v[80:95], v[24:27], v[36:39], v[80:95]
ds_read_b64_tr_b16 v[54:55], v10 offset:3840
ds_read_b64_tr_b16 v[56:57], v11 offset:3072
v_mfma_f32_32x32x16_bf16 v[96:111], v[24:27], v[40:43], v[96:111]
ds_read_b64_tr_b16 v[58:59], v11 offset:3840
ds_read_b64_tr_b16 v[60:61], v12 offset:3072
v_mfma_f32_32x32x16_bf16 v[112:127], v[28:31], v[32:35], v[112:127]
ds_read_b64_tr_b16 v[62:63], v12 offset:3840
v_mfma_f32_32x32x16_bf16 v[128:143], v[28:31], v[36:39], v[128:143]
v_mfma_f32_32x32x16_bf16 v[144:159], v[28:31], v[40:43], v[144:159]
s_add_u32 s43, s43, 28672
s_cmp_eq_u32 s43, 143360
s_cselect_b32 s42, -114688, s45
s_cselect_b32 s43, 0, s43
s_waitcnt lgkmcnt(0)
v_add_u32 v8, s42, v8
v_add_u32 v9, s42, v9
v_add_u32 v10, s42, v10
v_add_u32 v11, s42, v11
v_add_u32 v12, s42, v12
s_barrier
ds_read_b64_tr_b16 v[24:25], v8 offset:0
ds_read_b64_tr_b16 v[26:27], v8 offset:1024
ds_read_b64_tr_b16 v[28:29], v9 offset:0
v_mfma_f32_32x32x16_bf16 v[64:79], v[44:47], v[52:55], v[64:79]
ds_read_b64_tr_b16 v[30:31], v9 offset:1024
ds_read_b64_tr_b16 v[32:33], v10 offset:0
v_mfma_f32_32x32x16_bf16 v[80:95], v[44:47], v[56:59], v[80:95]
ds_read_b64_tr_b16 v[34:35], v10 offset:768
ds_read_b64_tr_b16 v[36:37], v11 offset:0
v_mfma_f32_32x32x16_bf16 v[96:111], v[44:47], v[60:63], v[96:111]
ds_read_b64_tr_b16 v[38:39], v11 offset:768
ds_read_b64_tr_b16 v[40:41], v12 offset:0
v_mfma_f32_32x32x16_bf16 v[112:127], v[48:51], v[52:55], v[112:127]
ds_read_b64_tr_b16 v[42:43], v12 offset:768
v_mfma_f32_32x32x16_bf16 v[128:143], v[48:51], v[56:59], v[128:143]
v_mfma_f32_32x32x16_bf16 v[144:159], v[48:51], v[60:63], v[144:159]
s_sub_u32 s40, s40, 1
s_cmp_lg_u32 s40, 0
s_cbranch_scc1 .mlp1_L3
s_waitcnt vmcnt(0) lgkmcnt(0)
s_nop 7
s_nop 7
s_barrier
s_mul_i32 s4, s3, 12288
v_lshl_add_u32 v1, v0, 4, s4
s_xor_b32 s5, s3, 2
s_mul_i32 s4, s5, 12288
v_lshl_add_u32 v2, v0, 4, s4
s_mul_i32 s4, s61, 864
s_lshl_b32 s5, s63, 1
s_add_u32 s4, s4, s5
s_lshl_b32 s64, s4, 10
v_lshlrev_b32 v3, 4, v0
s_mov_b32 s65, 0xbdd2d3e8
v_mov_b32 v4, 0xc0135761
v_lshlrev_b32 v8, 16, v160
v_and_b32 v9, 0xffff0000, v160
v_lshlrev_b32 v10, 16, v161
v_and_b32 v11, 0xffff0000, v161
v_lshlrev_b32 v12, 16, v162
v_and_b32 v13, 0xffff0000, v162
v_lshlrev_b32 v14, 16, v163
v_and_b32 v15, 0xffff0000, v163
v_lshlrev_b32 v16, 16, v164
v_and_b32 v17, 0xffff0000, v164
v_lshlrev_b32 v18, 16, v165
v_and_b32 v19, 0xffff0000, v165
v_lshlrev_b32 v20, 16, v166
v_and_b32 v21, 0xffff0000, v166
v_lshlrev_b32 v22, 16, v167
v_and_b32 v23, 0xffff0000, v167
s_cmp_eq_u32 s62, 0
s_cbranch_scc0 .mlp1_L4
ds_write_b128 v1, v[112:115] offset:0
ds_write_b128 v1, v[116:119] offset:1024
ds_write_b128 v1, v[120:123] offset:2048
ds_write_b128 v1, v[124:127] offset:3072
ds_write_b128 v1, v[128:131] offset:4096
ds_write_b128 v1, v[132:135] offset:5120
ds_write_b128 v1, v[136:139] offset:6144
ds_write_b128 v1, v[140:143] offset:7168
ds_write_b128 v1, v[144:147] offset:8192
ds_write_b128 v1, v[148:151] offset:9216
ds_write_b128 v1, v[152:155] offset:10240
ds_write_b128 v1, v[156:159] offset:11264
s_waitcnt lgkmcnt(0)
s_barrier
ds_read_b128 v[112:115], v2 offset:0
ds_read_b128 v[116:119], v2 offset:1024
ds_read_b128 v[120:123], v2 offset:2048
ds_read_b128 v[124:127], v2 offset:3072
ds_read_b128 v[128:131], v2 offset:4096
ds_read_b128 v[132:135], v2 offset:5120
ds_read_b128 v[136:139], v2 offset:6144
ds_read_b128 v[140:143], v2 offset:7168
ds_read_b128 v[144:147], v2 offset:8192
ds_read_b128 v[148:151], v2 offset:9216
ds_read_b128 v[152:155], v2 offset:10240
ds_read_b128 v[156:159], v2 offset:11264
v_add_f32 v64, v64, v8
v_add_f32 v65, v65, v9
v_add_f32 v66, v66, v10
v_add_f32 v67, v67, v11
v_add_f32 v68, v68, v12
v_add_f32 v69, v69, v13
v_add_f32 v70, v70, v14
v_add_f32 v71, v71, v15
v_add_f32 v72, v72, v16
v_add_f32 v73, v73, v17
v_add_f32 v74, v74, v18
v_add_f32 v75, v75, v19
v_add_f32 v76, v76, v20
v_add_f32 v77, v77, v21
v_add_f32 v78, v78, v22
v_add_f32 v79, v79, v23
v_add_f32 v80, v80, v8
v_add_f32 v81, v81, v9
v_add_f32 v82, v82, v10
v_add_f32 v83, v83, v11
v_add_f32 v84, v84, v12
v_add_f32 v85, v85, v13
v_add_f32 v86, v86, v14
v_add_f32 v87, v87, v15
v_add_f32 v88, v88, v16
v_add_f32 v89, v89, v17
v_add_f32 v90, v90, v18
v_add_f32 v91, v91, v19
v_add_f32 v92, v92, v20
v_add_f32 v93, v93, v21
v_add_f32 v94, v94, v22
v_add_f32 v95, v95, v23
v_add_f32 v96, v96, v8
v_add_f32 v97, v97, v9
v_add_f32 v98, v98, v10
v_add_f32 v99, v99, v11
v_add_f32 v100, v100, v12
v_add_f32 v101, v101, v13
v_add_f32 v102, v102, v14
v_add_f32 v103, v103, v15
v_add_f32 v104, v104, v16
v_add_f32 v105, v105, v17
v_add_f32 v106, v106, v18
v_add_f32 v107, v107, v19
v_add_f32 v108, v108, v20
v_add_f32 v109, v109, v21
v_add_f32 v110, v110, v22
v_add_f32 v111, v111, v23
s_waitcnt lgkmcnt(10)
v_add_f32 v64, v64, v112
v_add_f32 v65, v65, v113
v_add_f32 v66, v66, v114
v_add_f32 v67, v67, v115
v_add_f32 v68, v68, v116
v_add_f32 v69, v69, v117
v_add_f32 v70, v70, v118
v_add_f32 v71, v71, v119
v_mul_f32 v112, v64, v64
v_mul_f32 v113, v65, v65
v_mul_f32 v114, v66, v66
v_mul_f32 v115, v67, v67
v_mul_f32 v116, v68, v68
v_mul_f32 v117, v69, v69
v_mul_f32 v118, v70, v70
v_mul_f32 v119, v71, v71
v_fma_f32 v112, v112, s65, v4
v_fma_f32 v113, v113, s65, v4
v_fma_f32 v114, v114, s65, v4
v_fma_f32 v115, v115, s65, v4
v_fma_f32 v116, v116, s65, v4
v_fma_f32 v117, v117, s65, v4
v_fma_f32 v118, v118, s65, v4
v_fma_f32 v119, v119, s65, v4
v_mul_f32 v112, v112, v64
v_mul_f32 v113, v113, v65
v_mul_f32 v114, v114, v66
v_mul_f32 v115, v115, v67
v_mul_f32 v116, v116, v68
v_mul_f32 v117, v117, v69
v_mul_f32 v118, v118, v70
v_mul_f32 v119, v119, v71
v_exp_f32 v112, v112
v_exp_f32 v113, v113
v_exp_f32 v114, v114
v_exp_f32 v115, v115
v_exp_f32 v116, v116
v_exp_f32 v117, v117
v_exp_f32 v118, v118
v_exp_f32 v119, v119
v_add_f32 v112, 1.0, v112
v_add_f32 v113, 1.0, v113
v_add_f32 v114, 1.0, v114
v_add_f32 v115, 1.0, v115
v_add_f32 v116, 1.0, v116
v_add_f32 v117, 1.0, v117
v_add_f32 v118, 1.0, v118
v_add_f32 v119, 1.0, v119
v_rcp_f32 v112, v112
v_rcp_f32 v113, v113
v_rcp_f32 v114, v114
v_rcp_f32 v115, v115
v_rcp_f32 v116, v116
v_rcp_f32 v117, v117
v_rcp_f32 v118, v118
v_rcp_f32 v119, v119
v_mul_f32 v64, v64, v112
v_mul_f32 v65, v65, v113
v_mul_f32 v66, v66, v114
v_mul_f32 v67, v67, v115
v_mul_f32 v68, v68, v116
v_mul_f32 v69, v69, v117
v_mul_f32 v70, v70, v118
v_mul_f32 v71, v71, v119
v_cvt_pk_bf16_f32 v112, v64, v65
v_cvt_pk_bf16_f32 v113, v66, v67
v_cvt_pk_bf16_f32 v114, v68, v69
v_cvt_pk_bf16_f32 v115, v70, v71
buffer_store_dwordx4 v[112:115], v3, s[16:19], s64 offen offset:0 sc1
s_waitcnt lgkmcnt(8)
v_add_f32 v72, v72, v120
v_add_f32 v73, v73, v121
v_add_f32 v74, v74, v122
v_add_f32 v75, v75, v123
v_add_f32 v76, v76, v124
v_add_f32 v77, v77, v125
v_add_f32 v78, v78, v126
v_add_f32 v79, v79, v127
v_mul_f32 v120, v72, v72
v_mul_f32 v121, v73, v73
v_mul_f32 v122, v74, v74
v_mul_f32 v123, v75, v75
v_mul_f32 v124, v76, v76
v_mul_f32 v125, v77, v77
v_mul_f32 v126, v78, v78
v_mul_f32 v127, v79, v79
v_fma_f32 v120, v120, s65, v4
v_fma_f32 v121, v121, s65, v4
v_fma_f32 v122, v122, s65, v4
v_fma_f32 v123, v123, s65, v4
v_fma_f32 v124, v124, s65, v4
v_fma_f32 v125, v125, s65, v4
v_fma_f32 v126, v126, s65, v4
v_fma_f32 v127, v127, s65, v4
v_mul_f32 v120, v120, v72
v_mul_f32 v121, v121, v73
v_mul_f32 v122, v122, v74
v_mul_f32 v123, v123, v75
v_mul_f32 v124, v124, v76
v_mul_f32 v125, v125, v77
v_mul_f32 v126, v126, v78
v_mul_f32 v127, v127, v79
v_exp_f32 v120, v120
v_exp_f32 v121, v121
v_exp_f32 v122, v122
v_exp_f32 v123, v123
v_exp_f32 v124, v124
v_exp_f32 v125, v125
v_exp_f32 v126, v126
v_exp_f32 v127, v127
v_add_f32 v120, 1.0, v120
v_add_f32 v121, 1.0, v121
v_add_f32 v122, 1.0, v122
v_add_f32 v123, 1.0, v123
v_add_f32 v124, 1.0, v124
v_add_f32 v125, 1.0, v125
v_add_f32 v126, 1.0, v126
v_add_f32 v127, 1.0, v127
v_rcp_f32 v120, v120
v_rcp_f32 v121, v121
v_rcp_f32 v122, v122
v_rcp_f32 v123, v123
v_rcp_f32 v124, v124
v_rcp_f32 v125, v125
v_rcp_f32 v126, v126
v_rcp_f32 v127, v127
v_mul_f32 v72, v72, v120
v_mul_f32 v73, v73, v121
v_mul_f32 v74, v74, v122
v_mul_f32 v75, v75, v123
v_mul_f32 v76, v76, v124
v_mul_f32 v77, v77, v125
v_mul_f32 v78, v78, v126
v_mul_f32 v79, v79, v127
v_cvt_pk_bf16_f32 v120, v72, v73
v_cvt_pk_bf16_f32 v121, v74, v75
v_cvt_pk_bf16_f32 v122, v76, v77
v_cvt_pk_bf16_f32 v123, v78, v79
buffer_store_dwordx4 v[120:123], v3, s[16:19], s64 offen offset:1024 sc1
s_add_u32 s64, s64, 294912
s_waitcnt lgkmcnt(6)
v_add_f32 v80, v80, v128
v_add_f32 v81, v81, v129
v_add_f32 v82, v82, v130
v_add_f32 v83, v83, v131
v_add_f32 v84, v84, v132
v_add_f32 v85, v85, v133
v_add_f32 v86, v86, v134
v_add_f32 v87, v87, v135
v_mul_f32 v128, v80, v80
v_mul_f32 v129, v81, v81
v_mul_f32 v130, v82, v82
v_mul_f32 v131, v83, v83
v_mul_f32 v132, v84, v84
v_mul_f32 v133, v85, v85
v_mul_f32 v134, v86, v86
v_mul_f32 v135, v87, v87
v_fma_f32 v128, v128, s65, v4
v_fma_f32 v129, v129, s65, v4
v_fma_f32 v130, v130, s65, v4
v_fma_f32 v131, v131, s65, v4
v_fma_f32 v132, v132, s65, v4
v_fma_f32 v133, v133, s65, v4
v_fma_f32 v134, v134, s65, v4
v_fma_f32 v135, v135, s65, v4
v_mul_f32 v128, v128, v80
v_mul_f32 v129, v129, v81
v_mul_f32 v130, v130, v82
v_mul_f32 v131, v131, v83
v_mul_f32 v132, v132, v84
v_mul_f32 v133, v133, v85
v_mul_f32 v134, v134, v86
v_mul_f32 v135, v135, v87
v_exp_f32 v128, v128
v_exp_f32 v129, v129
v_exp_f32 v130, v130
v_exp_f32 v131, v131
v_exp_f32 v132, v132
v_exp_f32 v133, v133
v_exp_f32 v134, v134
v_exp_f32 v135, v135
v_add_f32 v128, 1.0, v128
v_add_f32 v129, 1.0, v129
v_add_f32 v130, 1.0, v130
v_add_f32 v131, 1.0, v131
v_add_f32 v132, 1.0, v132
v_add_f32 v133, 1.0, v133
v_add_f32 v134, 1.0, v134
v_add_f32 v135, 1.0, v135
v_rcp_f32 v128, v128
v_rcp_f32 v129, v129
v_rcp_f32 v130, v130
v_rcp_f32 v131, v131
v_rcp_f32 v132, v132
v_rcp_f32 v133, v133
v_rcp_f32 v134, v134
v_rcp_f32 v135, v135
v_mul_f32 v80, v80, v128
v_mul_f32 v81, v81, v129
v_mul_f32 v82, v82, v130
v_mul_f32 v83, v83, v131
v_mul_f32 v84, v84, v132
v_mul_f32 v85, v85, v133
v_mul_f32 v86, v86, v134
v_mul_f32 v87, v87, v135
v_cvt_pk_bf16_f32 v128, v80, v81
v_cvt_pk_bf16_f32 v129, v82, v83
v_cvt_pk_bf16_f32 v130, v84, v85
v_cvt_pk_bf16_f32 v131, v86, v87
buffer_store_dwordx4 v[128:131], v3, s[16:19], s64 offen offset:0 sc1
s_waitcnt lgkmcnt(4)
v_add_f32 v88, v88, v136
v_add_f32 v89, v89, v137
v_add_f32 v90, v90, v138
v_add_f32 v91, v91, v139
v_add_f32 v92, v92, v140
v_add_f32 v93, v93, v141
v_add_f32 v94, v94, v142
v_add_f32 v95, v95, v143
v_mul_f32 v136, v88, v88
v_mul_f32 v137, v89, v89
v_mul_f32 v138, v90, v90
v_mul_f32 v139, v91, v91
v_mul_f32 v140, v92, v92
v_mul_f32 v141, v93, v93
v_mul_f32 v142, v94, v94
v_mul_f32 v143, v95, v95
v_fma_f32 v136, v136, s65, v4
v_fma_f32 v137, v137, s65, v4
v_fma_f32 v138, v138, s65, v4
v_fma_f32 v139, v139, s65, v4
v_fma_f32 v140, v140, s65, v4
v_fma_f32 v141, v141, s65, v4
v_fma_f32 v142, v142, s65, v4
v_fma_f32 v143, v143, s65, v4
v_mul_f32 v136, v136, v88
v_mul_f32 v137, v137, v89
v_mul_f32 v138, v138, v90
v_mul_f32 v139, v139, v91
v_mul_f32 v140, v140, v92
v_mul_f32 v141, v141, v93
v_mul_f32 v142, v142, v94
v_mul_f32 v143, v143, v95
v_exp_f32 v136, v136
v_exp_f32 v137, v137
v_exp_f32 v138, v138
v_exp_f32 v139, v139
v_exp_f32 v140, v140
v_exp_f32 v141, v141
v_exp_f32 v142, v142
v_exp_f32 v143, v143
v_add_f32 v136, 1.0, v136
v_add_f32 v137, 1.0, v137
v_add_f32 v138, 1.0, v138
v_add_f32 v139, 1.0, v139
v_add_f32 v140, 1.0, v140
v_add_f32 v141, 1.0, v141
v_add_f32 v142, 1.0, v142
v_add_f32 v143, 1.0, v143
v_rcp_f32 v136, v136
v_rcp_f32 v137, v137
v_rcp_f32 v138, v138
v_rcp_f32 v139, v139
v_rcp_f32 v140, v140
v_rcp_f32 v141, v141
v_rcp_f32 v142, v142
v_rcp_f32 v143, v143
v_mul_f32 v88, v88, v136
v_mul_f32 v89, v89, v137
v_mul_f32 v90, v90, v138
v_mul_f32 v91, v91, v139
v_mul_f32 v92, v92, v140
v_mul_f32 v93, v93, v141
v_mul_f32 v94, v94, v142
v_mul_f32 v95, v95, v143
v_cvt_pk_bf16_f32 v136, v88, v89
v_cvt_pk_bf16_f32 v137, v90, v91
v_cvt_pk_bf16_f32 v138, v92, v93
v_cvt_pk_bf16_f32 v139, v94, v95
buffer_store_dwordx4 v[136:139], v3, s[16:19], s64 offen offset:1024 sc1
s_add_u32 s64, s64, 294912
s_waitcnt lgkmcnt(2)
v_add_f32 v96, v96, v144
v_add_f32 v97, v97, v145
v_add_f32 v98, v98, v146
v_add_f32 v99, v99, v147
v_add_f32 v100, v100, v148
v_add_f32 v101, v101, v149
v_add_f32 v102, v102, v150
v_add_f32 v103, v103, v151
v_mul_f32 v144, v96, v96
v_mul_f32 v145, v97, v97
v_mul_f32 v146, v98, v98
v_mul_f32 v147, v99, v99
v_mul_f32 v148, v100, v100
v_mul_f32 v149, v101, v101
v_mul_f32 v150, v102, v102
v_mul_f32 v151, v103, v103
v_fma_f32 v144, v144, s65, v4
v_fma_f32 v145, v145, s65, v4
v_fma_f32 v146, v146, s65, v4
v_fma_f32 v147, v147, s65, v4
v_fma_f32 v148, v148, s65, v4
v_fma_f32 v149, v149, s65, v4
v_fma_f32 v150, v150, s65, v4
v_fma_f32 v151, v151, s65, v4
v_mul_f32 v144, v144, v96
v_mul_f32 v145, v145, v97
v_mul_f32 v146, v146, v98
v_mul_f32 v147, v147, v99
v_mul_f32 v148, v148, v100
v_mul_f32 v149, v149, v101
v_mul_f32 v150, v150, v102
v_mul_f32 v151, v151, v103
v_exp_f32 v144, v144
v_exp_f32 v145, v145
v_exp_f32 v146, v146
v_exp_f32 v147, v147
v_exp_f32 v148, v148
v_exp_f32 v149, v149
v_exp_f32 v150, v150
v_exp_f32 v151, v151
v_add_f32 v144, 1.0, v144
v_add_f32 v145, 1.0, v145
v_add_f32 v146, 1.0, v146
v_add_f32 v147, 1.0, v147
v_add_f32 v148, 1.0, v148
v_add_f32 v149, 1.0, v149
v_add_f32 v150, 1.0, v150
v_add_f32 v151, 1.0, v151
v_rcp_f32 v144, v144
v_rcp_f32 v145, v145
v_rcp_f32 v146, v146
v_rcp_f32 v147, v147
v_rcp_f32 v148, v148
v_rcp_f32 v149, v149
v_rcp_f32 v150, v150
v_rcp_f32 v151, v151
v_mul_f32 v96, v96, v144
v_mul_f32 v97, v97, v145
v_mul_f32 v98, v98, v146
v_mul_f32 v99, v99, v147
v_mul_f32 v100, v100, v148
v_mul_f32 v101, v101, v149
v_mul_f32 v102, v102, v150
v_mul_f32 v103, v103, v151
v_cvt_pk_bf16_f32 v144, v96, v97
v_cvt_pk_bf16_f32 v145, v98, v99
v_cvt_pk_bf16_f32 v146, v100, v101
v_cvt_pk_bf16_f32 v147, v102, v103
buffer_store_dwordx4 v[144:147], v3, s[16:19], s64 offen offset:0 sc1
s_waitcnt lgkmcnt(0)
v_add_f32 v104, v104, v152
v_add_f32 v105, v105, v153
v_add_f32 v106, v106, v154
v_add_f32 v107, v107, v155
v_add_f32 v108, v108, v156
v_add_f32 v109, v109, v157
v_add_f32 v110, v110, v158
v_add_f32 v111, v111, v159
v_mul_f32 v152, v104, v104
v_mul_f32 v153, v105, v105
v_mul_f32 v154, v106, v106
v_mul_f32 v155, v107, v107
v_mul_f32 v156, v108, v108
v_mul_f32 v157, v109, v109
v_mul_f32 v158, v110, v110
v_mul_f32 v159, v111, v111
v_fma_f32 v152, v152, s65, v4
v_fma_f32 v153, v153, s65, v4
v_fma_f32 v154, v154, s65, v4
v_fma_f32 v155, v155, s65, v4
v_fma_f32 v156, v156, s65, v4
v_fma_f32 v157, v157, s65, v4
v_fma_f32 v158, v158, s65, v4
v_fma_f32 v159, v159, s65, v4
v_mul_f32 v152, v152, v104
v_mul_f32 v153, v153, v105
v_mul_f32 v154, v154, v106
v_mul_f32 v155, v155, v107
v_mul_f32 v156, v156, v108
v_mul_f32 v157, v157, v109
v_mul_f32 v158, v158, v110
v_mul_f32 v159, v159, v111
v_exp_f32 v152, v152
v_exp_f32 v153, v153
v_exp_f32 v154, v154
v_exp_f32 v155, v155
v_exp_f32 v156, v156
v_exp_f32 v157, v157
v_exp_f32 v158, v158
v_exp_f32 v159, v159
v_add_f32 v152, 1.0, v152
v_add_f32 v153, 1.0, v153
v_add_f32 v154, 1.0, v154
v_add_f32 v155, 1.0, v155
v_add_f32 v156, 1.0, v156
v_add_f32 v157, 1.0, v157
v_add_f32 v158, 1.0, v158
v_add_f32 v159, 1.0, v159
v_rcp_f32 v152, v152
v_rcp_f32 v153, v153
v_rcp_f32 v154, v154
v_rcp_f32 v155, v155
v_rcp_f32 v156, v156
v_rcp_f32 v157, v157
v_rcp_f32 v158, v158
v_rcp_f32 v159, v159
v_mul_f32 v104, v104, v152
v_mul_f32 v105, v105, v153
v_mul_f32 v106, v106, v154
v_mul_f32 v107, v107, v155
v_mul_f32 v108, v108, v156
v_mul_f32 v109, v109, v157
v_mul_f32 v110, v110, v158
v_mul_f32 v111, v111, v159
v_cvt_pk_bf16_f32 v152, v104, v105
v_cvt_pk_bf16_f32 v153, v106, v107
v_cvt_pk_bf16_f32 v154, v108, v109
v_cvt_pk_bf16_f32 v155, v110, v111
buffer_store_dwordx4 v[152:155], v3, s[16:19], s64 offen offset:1024 sc1
s_add_u32 s64, s64, 294912
s_endpgm
.mlp1_L4:
ds_write_b128 v1, v[64:67] offset:0
ds_write_b128 v1, v[68:71] offset:1024
ds_write_b128 v1, v[72:75] offset:2048
ds_write_b128 v1, v[76:79] offset:3072
ds_write_b128 v1, v[80:83] offset:4096
ds_write_b128 v1, v[84:87] offset:5120
ds_write_b128 v1, v[88:91] offset:6144
ds_write_b128 v1, v[92:95] offset:7168
ds_write_b128 v1, v[96:99] offset:8192
ds_write_b128 v1, v[100:103] offset:9216
ds_write_b128 v1, v[104:107] offset:10240
ds_write_b128 v1, v[108:111] offset:11264
s_waitcnt lgkmcnt(0)
s_barrier
ds_read_b128 v[64:67], v2 offset:0
ds_read_b128 v[68:71], v2 offset:1024
ds_read_b128 v[72:75], v2 offset:2048
ds_read_b128 v[76:79], v2 offset:3072
ds_read_b128 v[80:83], v2 offset:4096
ds_read_b128 v[84:87], v2 offset:5120
ds_read_b128 v[88:91], v2 offset:6144
ds_read_b128 v[92:95], v2 offset:7168
ds_read_b128 v[96:99], v2 offset:8192
ds_read_b128 v[100:103], v2 offset:9216
ds_read_b128 v[104:107], v2 offset:10240
ds_read_b128 v[108:111], v2 offset:11264
v_add_f32 v112, v112, v8
v_add_f32 v113, v113, v9
v_add_f32 v114, v114, v10
v_add_f32 v115, v115, v11
v_add_f32 v116, v116, v12
v_add_f32 v117, v117, v13
v_add_f32 v118, v118, v14
v_add_f32 v119, v119, v15
v_add_f32 v120, v120, v16
v_add_f32 v121, v121, v17
v_add_f32 v122, v122, v18
v_add_f32 v123, v123, v19
v_add_f32 v124, v124, v20
v_add_f32 v125, v125, v21
v_add_f32 v126, v126, v22
v_add_f32 v127, v127, v23
v_add_f32 v128, v128, v8
v_add_f32 v129, v129, v9
v_add_f32 v130, v130, v10
v_add_f32 v131, v131, v11
v_add_f32 v132, v132, v12
v_add_f32 v133, v133, v13
v_add_f32 v134, v134, v14
v_add_f32 v135, v135, v15
v_add_f32 v136, v136, v16
v_add_f32 v137, v137, v17
v_add_f32 v138, v138, v18
v_add_f32 v139, v139, v19
v_add_f32 v140, v140, v20
v_add_f32 v141, v141, v21
v_add_f32 v142, v142, v22
v_add_f32 v143, v143, v23
v_add_f32 v144, v144, v8
v_add_f32 v145, v145, v9
v_add_f32 v146, v146, v10
v_add_f32 v147, v147, v11
v_add_f32 v148, v148, v12
v_add_f32 v149, v149, v13
v_add_f32 v150, v150, v14
v_add_f32 v151, v151, v15
v_add_f32 v152, v152, v16
v_add_f32 v153, v153, v17
v_add_f32 v154, v154, v18
v_add_f32 v155, v155, v19
v_add_f32 v156, v156, v20
v_add_f32 v157, v157, v21
v_add_f32 v158, v158, v22
v_add_f32 v159, v159, v23
s_waitcnt lgkmcnt(10)
v_add_f32 v112, v112, v64
v_add_f32 v113, v113, v65
v_add_f32 v114, v114, v66
v_add_f32 v115, v115, v67
v_add_f32 v116, v116, v68
v_add_f32 v117, v117, v69
v_add_f32 v118, v118, v70
v_add_f32 v119, v119, v71
v_mul_f32 v64, v112, v112
v_mul_f32 v65, v113, v113
v_mul_f32 v66, v114, v114
v_mul_f32 v67, v115, v115
v_mul_f32 v68, v116, v116
v_mul_f32 v69, v117, v117
v_mul_f32 v70, v118, v118
v_mul_f32 v71, v119, v119
v_fma_f32 v64, v64, s65, v4
v_fma_f32 v65, v65, s65, v4
v_fma_f32 v66, v66, s65, v4
v_fma_f32 v67, v67, s65, v4
v_fma_f32 v68, v68, s65, v4
v_fma_f32 v69, v69, s65, v4
v_fma_f32 v70, v70, s65, v4
v_fma_f32 v71, v71, s65, v4
v_mul_f32 v64, v64, v112
v_mul_f32 v65, v65, v113
v_mul_f32 v66, v66, v114
v_mul_f32 v67, v67, v115
v_mul_f32 v68, v68, v116
v_mul_f32 v69, v69, v117
v_mul_f32 v70, v70, v118
v_mul_f32 v71, v71, v119
v_exp_f32 v64, v64
v_exp_f32 v65, v65
v_exp_f32 v66, v66
v_exp_f32 v67, v67
v_exp_f32 v68, v68
v_exp_f32 v69, v69
v_exp_f32 v70, v70
v_exp_f32 v71, v71
v_add_f32 v64, 1.0, v64
v_add_f32 v65, 1.0, v65
v_add_f32 v66, 1.0, v66
v_add_f32 v67, 1.0, v67
v_add_f32 v68, 1.0, v68
v_add_f32 v69, 1.0, v69
v_add_f32 v70, 1.0, v70
v_add_f32 v71, 1.0, v71
v_rcp_f32 v64, v64
v_rcp_f32 v65, v65
v_rcp_f32 v66, v66
v_rcp_f32 v67, v67
v_rcp_f32 v68, v68
v_rcp_f32 v69, v69
v_rcp_f32 v70, v70
v_rcp_f32 v71, v71
v_mul_f32 v112, v112, v64
v_mul_f32 v113, v113, v65
v_mul_f32 v114, v114, v66
v_mul_f32 v115, v115, v67
v_mul_f32 v116, v116, v68
v_mul_f32 v117, v117, v69
v_mul_f32 v118, v118, v70
v_mul_f32 v119, v119, v71
v_cvt_pk_bf16_f32 v64, v112, v113
v_cvt_pk_bf16_f32 v65, v114, v115
v_cvt_pk_bf16_f32 v66, v116, v117
v_cvt_pk_bf16_f32 v67, v118, v119
buffer_store_dwordx4 v[64:67], v3, s[16:19], s64 offen offset:0 sc1
s_waitcnt lgkmcnt(8)
v_add_f32 v120, v120, v72
v_add_f32 v121, v121, v73
v_add_f32 v122, v122, v74
v_add_f32 v123, v123, v75
v_add_f32 v124, v124, v76
v_add_f32 v125, v125, v77
v_add_f32 v126, v126, v78
v_add_f32 v127, v127, v79
v_mul_f32 v72, v120, v120
v_mul_f32 v73, v121, v121
v_mul_f32 v74, v122, v122
v_mul_f32 v75, v123, v123
v_mul_f32 v76, v124, v124
v_mul_f32 v77, v125, v125
v_mul_f32 v78, v126, v126
v_mul_f32 v79, v127, v127
v_fma_f32 v72, v72, s65, v4
v_fma_f32 v73, v73, s65, v4
v_fma_f32 v74, v74, s65, v4
v_fma_f32 v75, v75, s65, v4
v_fma_f32 v76, v76, s65, v4
v_fma_f32 v77, v77, s65, v4
v_fma_f32 v78, v78, s65, v4
v_fma_f32 v79, v79, s65, v4
v_mul_f32 v72, v72, v120
v_mul_f32 v73, v73, v121
v_mul_f32 v74, v74, v122
v_mul_f32 v75, v75, v123
v_mul_f32 v76, v76, v124
v_mul_f32 v77, v77, v125
v_mul_f32 v78, v78, v126
v_mul_f32 v79, v79, v127
v_exp_f32 v72, v72
v_exp_f32 v73, v73
v_exp_f32 v74, v74
v_exp_f32 v75, v75
v_exp_f32 v76, v76
v_exp_f32 v77, v77
v_exp_f32 v78, v78
v_exp_f32 v79, v79
v_add_f32 v72, 1.0, v72
v_add_f32 v73, 1.0, v73
v_add_f32 v74, 1.0, v74
v_add_f32 v75, 1.0, v75
v_add_f32 v76, 1.0, v76
v_add_f32 v77, 1.0, v77
v_add_f32 v78, 1.0, v78
v_add_f32 v79, 1.0, v79
v_rcp_f32 v72, v72
v_rcp_f32 v73, v73
v_rcp_f32 v74, v74
v_rcp_f32 v75, v75
v_rcp_f32 v76, v76
v_rcp_f32 v77, v77
v_rcp_f32 v78, v78
v_rcp_f32 v79, v79
v_mul_f32 v120, v120, v72
v_mul_f32 v121, v121, v73
v_mul_f32 v122, v122, v74
v_mul_f32 v123, v123, v75
v_mul_f32 v124, v124, v76
v_mul_f32 v125, v125, v77
v_mul_f32 v126, v126, v78
v_mul_f32 v127, v127, v79
v_cvt_pk_bf16_f32 v72, v120, v121
v_cvt_pk_bf16_f32 v73, v122, v123
v_cvt_pk_bf16_f32 v74, v124, v125
v_cvt_pk_bf16_f32 v75, v126, v127
buffer_store_dwordx4 v[72:75], v3, s[16:19], s64 offen offset:1024 sc1
s_add_u32 s64, s64, 294912
s_waitcnt lgkmcnt(6)
v_add_f32 v128, v128, v80
v_add_f32 v129, v129, v81
v_add_f32 v130, v130, v82
v_add_f32 v131, v131, v83
v_add_f32 v132, v132, v84
v_add_f32 v133, v133, v85
v_add_f32 v134, v134, v86
v_add_f32 v135, v135, v87
v_mul_f32 v80, v128, v128
v_mul_f32 v81, v129, v129
v_mul_f32 v82, v130, v130
v_mul_f32 v83, v131, v131
v_mul_f32 v84, v132, v132
v_mul_f32 v85, v133, v133
v_mul_f32 v86, v134, v134
v_mul_f32 v87, v135, v135
v_fma_f32 v80, v80, s65, v4
v_fma_f32 v81, v81, s65, v4
v_fma_f32 v82, v82, s65, v4
v_fma_f32 v83, v83, s65, v4
v_fma_f32 v84, v84, s65, v4
v_fma_f32 v85, v85, s65, v4
v_fma_f32 v86, v86, s65, v4
v_fma_f32 v87, v87, s65, v4
v_mul_f32 v80, v80, v128
v_mul_f32 v81, v81, v129
v_mul_f32 v82, v82, v130
v_mul_f32 v83, v83, v131
v_mul_f32 v84, v84, v132
v_mul_f32 v85, v85, v133
v_mul_f32 v86, v86, v134
v_mul_f32 v87, v87, v135
v_exp_f32 v80, v80
v_exp_f32 v81, v81
v_exp_f32 v82, v82
v_exp_f32 v83, v83
v_exp_f32 v84, v84
v_exp_f32 v85, v85
v_exp_f32 v86, v86
v_exp_f32 v87, v87
v_add_f32 v80, 1.0, v80
v_add_f32 v81, 1.0, v81
v_add_f32 v82, 1.0, v82
v_add_f32 v83, 1.0, v83
v_add_f32 v84, 1.0, v84
v_add_f32 v85, 1.0, v85
v_add_f32 v86, 1.0, v86
v_add_f32 v87, 1.0, v87
v_rcp_f32 v80, v80
v_rcp_f32 v81, v81
v_rcp_f32 v82, v82
v_rcp_f32 v83, v83
v_rcp_f32 v84, v84
v_rcp_f32 v85, v85
v_rcp_f32 v86, v86
v_rcp_f32 v87, v87
v_mul_f32 v128, v128, v80
v_mul_f32 v129, v129, v81
v_mul_f32 v130, v130, v82
v_mul_f32 v131, v131, v83
v_mul_f32 v132, v132, v84
v_mul_f32 v133, v133, v85
v_mul_f32 v134, v134, v86
v_mul_f32 v135, v135, v87
v_cvt_pk_bf16_f32 v80, v128, v129
v_cvt_pk_bf16_f32 v81, v130, v131
v_cvt_pk_bf16_f32 v82, v132, v133
v_cvt_pk_bf16_f32 v83, v134, v135
buffer_store_dwordx4 v[80:83], v3, s[16:19], s64 offen offset:0 sc1
s_waitcnt lgkmcnt(4)
v_add_f32 v136, v136, v88
v_add_f32 v137, v137, v89
v_add_f32 v138, v138, v90
v_add_f32 v139, v139, v91
v_add_f32 v140, v140, v92
v_add_f32 v141, v141, v93
v_add_f32 v142, v142, v94
v_add_f32 v143, v143, v95
v_mul_f32 v88, v136, v136
v_mul_f32 v89, v137, v137
v_mul_f32 v90, v138, v138
v_mul_f32 v91, v139, v139
v_mul_f32 v92, v140, v140
v_mul_f32 v93, v141, v141
v_mul_f32 v94, v142, v142
v_mul_f32 v95, v143, v143
v_fma_f32 v88, v88, s65, v4
v_fma_f32 v89, v89, s65, v4
v_fma_f32 v90, v90, s65, v4
v_fma_f32 v91, v91, s65, v4
v_fma_f32 v92, v92, s65, v4
v_fma_f32 v93, v93, s65, v4
v_fma_f32 v94, v94, s65, v4
v_fma_f32 v95, v95, s65, v4
v_mul_f32 v88, v88, v136
v_mul_f32 v89, v89, v137
v_mul_f32 v90, v90, v138
v_mul_f32 v91, v91, v139
v_mul_f32 v92, v92, v140
v_mul_f32 v93, v93, v141
v_mul_f32 v94, v94, v142
v_mul_f32 v95, v95, v143
v_exp_f32 v88, v88
v_exp_f32 v89, v89
v_exp_f32 v90, v90
v_exp_f32 v91, v91
v_exp_f32 v92, v92
v_exp_f32 v93, v93
v_exp_f32 v94, v94
v_exp_f32 v95, v95
v_add_f32 v88, 1.0, v88
v_add_f32 v89, 1.0, v89
v_add_f32 v90, 1.0, v90
v_add_f32 v91, 1.0, v91
v_add_f32 v92, 1.0, v92
v_add_f32 v93, 1.0, v93
v_add_f32 v94, 1.0, v94
v_add_f32 v95, 1.0, v95
v_rcp_f32 v88, v88
v_rcp_f32 v89, v89
v_rcp_f32 v90, v90
v_rcp_f32 v91, v91
v_rcp_f32 v92, v92
v_rcp_f32 v93, v93
v_rcp_f32 v94, v94
v_rcp_f32 v95, v95
v_mul_f32 v136, v136, v88
v_mul_f32 v137, v137, v89
v_mul_f32 v138, v138, v90
v_mul_f32 v139, v139, v91
v_mul_f32 v140, v140, v92
v_mul_f32 v141, v141, v93
v_mul_f32 v142, v142, v94
v_mul_f32 v143, v143, v95
v_cvt_pk_bf16_f32 v88, v136, v137
v_cvt_pk_bf16_f32 v89, v138, v139
v_cvt_pk_bf16_f32 v90, v140, v141
v_cvt_pk_bf16_f32 v91, v142, v143
buffer_store_dwordx4 v[88:91], v3, s[16:19], s64 offen offset:1024 sc1
s_add_u32 s64, s64, 294912
s_waitcnt lgkmcnt(2)
v_add_f32 v144, v144, v96
v_add_f32 v145, v145, v97
v_add_f32 v146, v146, v98
v_add_f32 v147, v147, v99
v_add_f32 v148, v148, v100
v_add_f32 v149, v149, v101
v_add_f32 v150, v150, v102
v_add_f32 v151, v151, v103
v_mul_f32 v96, v144, v144
v_mul_f32 v97, v145, v145
v_mul_f32 v98, v146, v146
v_mul_f32 v99, v147, v147
v_mul_f32 v100, v148, v148
v_mul_f32 v101, v149, v149
v_mul_f32 v102, v150, v150
v_mul_f32 v103, v151, v151
v_fma_f32 v96, v96, s65, v4
v_fma_f32 v97, v97, s65, v4
v_fma_f32 v98, v98, s65, v4
v_fma_f32 v99, v99, s65, v4
v_fma_f32 v100, v100, s65, v4
v_fma_f32 v101, v101, s65, v4
v_fma_f32 v102, v102, s65, v4
v_fma_f32 v103, v103, s65, v4
v_mul_f32 v96, v96, v144
v_mul_f32 v97, v97, v145
v_mul_f32 v98, v98, v146
v_mul_f32 v99, v99, v147
v_mul_f32 v100, v100, v148
v_mul_f32 v101, v101, v149
v_mul_f32 v102, v102, v150
v_mul_f32 v103, v103, v151
v_exp_f32 v96, v96
v_exp_f32 v97, v97
v_exp_f32 v98, v98
v_exp_f32 v99, v99
v_exp_f32 v100, v100
v_exp_f32 v101, v101
v_exp_f32 v102, v102
v_exp_f32 v103, v103
v_add_f32 v96, 1.0, v96
v_add_f32 v97, 1.0, v97
v_add_f32 v98, 1.0, v98
v_add_f32 v99, 1.0, v99
v_add_f32 v100, 1.0, v100
v_add_f32 v101, 1.0, v101
v_add_f32 v102, 1.0, v102
v_add_f32 v103, 1.0, v103
v_rcp_f32 v96, v96
v_rcp_f32 v97, v97
v_rcp_f32 v98, v98
v_rcp_f32 v99, v99
v_rcp_f32 v100, v100
v_rcp_f32 v101, v101
v_rcp_f32 v102, v102
v_rcp_f32 v103, v103
v_mul_f32 v144, v144, v96
v_mul_f32 v145, v145, v97
v_mul_f32 v146, v146, v98
v_mul_f32 v147, v147, v99
v_mul_f32 v148, v148, v100
v_mul_f32 v149, v149, v101
v_mul_f32 v150, v150, v102
v_mul_f32 v151, v151, v103
v_cvt_pk_bf16_f32 v96, v144, v145
v_cvt_pk_bf16_f32 v97, v146, v147
v_cvt_pk_bf16_f32 v98, v148, v149
v_cvt_pk_bf16_f32 v99, v150, v151
buffer_store_dwordx4 v[96:99], v3, s[16:19], s64 offen offset:0 sc1
s_waitcnt lgkmcnt(0)
v_add_f32 v152, v152, v104
v_add_f32 v153, v153, v105
v_add_f32 v154, v154, v106
v_add_f32 v155, v155, v107
v_add_f32 v156, v156, v108
v_add_f32 v157, v157, v109
v_add_f32 v158, v158, v110
v_add_f32 v159, v159, v111
v_mul_f32 v104, v152, v152
v_mul_f32 v105, v153, v153
v_mul_f32 v106, v154, v154
v_mul_f32 v107, v155, v155
v_mul_f32 v108, v156, v156
v_mul_f32 v109, v157, v157
v_mul_f32 v110, v158, v158
v_mul_f32 v111, v159, v159
v_fma_f32 v104, v104, s65, v4
v_fma_f32 v105, v105, s65, v4
v_fma_f32 v106, v106, s65, v4
v_fma_f32 v107, v107, s65, v4
v_fma_f32 v108, v108, s65, v4
v_fma_f32 v109, v109, s65, v4
v_fma_f32 v110, v110, s65, v4
v_fma_f32 v111, v111, s65, v4
v_mul_f32 v104, v104, v152
v_mul_f32 v105, v105, v153
v_mul_f32 v106, v106, v154
v_mul_f32 v107, v107, v155
v_mul_f32 v108, v108, v156
v_mul_f32 v109, v109, v157
v_mul_f32 v110, v110, v158
v_mul_f32 v111, v111, v159
v_exp_f32 v104, v104
v_exp_f32 v105, v105
v_exp_f32 v106, v106
v_exp_f32 v107, v107
v_exp_f32 v108, v108
v_exp_f32 v109, v109
v_exp_f32 v110, v110
v_exp_f32 v111, v111
v_add_f32 v104, 1.0, v104
v_add_f32 v105, 1.0, v105
v_add_f32 v106, 1.0, v106
v_add_f32 v107, 1.0, v107
v_add_f32 v108, 1.0, v108
v_add_f32 v109, 1.0, v109
v_add_f32 v110, 1.0, v110
v_add_f32 v111, 1.0, v111
v_rcp_f32 v104, v104
v_rcp_f32 v105, v105
v_rcp_f32 v106, v106
v_rcp_f32 v107, v107
v_rcp_f32 v108, v108
v_rcp_f32 v109, v109
v_rcp_f32 v110, v110
v_rcp_f32 v111, v111
v_mul_f32 v152, v152, v104
v_mul_f32 v153, v153, v105
v_mul_f32 v154, v154, v106
v_mul_f32 v155, v155, v107
v_mul_f32 v156, v156, v108
v_mul_f32 v157, v157, v109
v_mul_f32 v158, v158, v110
v_mul_f32 v159, v159, v111
v_cvt_pk_bf16_f32 v104, v152, v153
v_cvt_pk_bf16_f32 v105, v154, v155
v_cvt_pk_bf16_f32 v106, v156, v157
v_cvt_pk_bf16_f32 v107, v158, v159
buffer_store_dwordx4 v[104:107], v3, s[16:19], s64 offen offset:1024 sc1
s_add_u32 s64, s64, 294912
s_endpgm
.mlp1_end:
s_endpgm
.globl mlp2_kernel
.p2align 8
.type mlp2_kernel,@function
mlp2_kernel:
s_cmp_ge_u32 s2, 240
s_cbranch_scc1 .mlp2_end
v_readfirstlane_b32 s3, v0
v_and_b32 v0, 63, v0
s_lshr_b32 s3, s3, 6
s_and_b32 s4, s2, 7
s_mul_i32 s4, s4, 30
s_lshr_b32 s5, s2, 3
s_add_u32 s4, s4, s5
s_mul_i32 s5, s4, 171
s_lshr_b32 s5, s5, 9
s_mul_i32 s6, s5, 3
s_sub_u32 s61, s4, s6
s_lshr_b32 s60, s5, 4
s_and_b32 s62, s5, 15
s_and_b32 s68, s62, 3
s_load_dwordx2 s[8:9], s[0:1], 104
s_load_dwordx2 s[12:13], s[0:1], 72
s_load_dwordx2 s[16:17], s[0:1], 104
s_mul_i32 s63, s60, 14
s_min_u32 s4, s60, 2
s_add_u32 s63, s63, s4
s_cmp_lt_u32 s60, 2
s_cselect_b32 s64, 15, 14
s_mul_i32 s50, s61, 1769472
s_lshl_b32 s4, s63, 12
s_add_u32 s50, s50, s4
s_lshl_b32 s51, s63, 18
s_lshl_b32 s4, s62, 8
s_add_u32 s51, s51, s4
s_and_b32 s56, s3, 1
s_mul_i32 s56, s56, 3
s_and_b32 s57, s3, 2
s_cmp_lt_u32 s3, 4
s_cbranch_scc1 .mlp2_L1
s_sub_u32 s3, s3, 4
s_mul_i32 s4, s3, 6
s_add_u32 s4, s4, 0
s_lshr_b32 s5, s4, 2
s_mul_i32 s5, s5, 294912
s_and_b32 s4, s4, 3
s_lshl_b32 s4, s4, 10
s_add_u32 s4, s4, s5
v_lshl_add_u32 v8, v0, 4, s4
s_mul_i32 s4, s3, 6
s_add_u32 s4, s4, 1
s_lshr_b32 s5, s4, 2
s_mul_i32 s5, s5, 294912
s_and_b32 s4, s4, 3
s_lshl_b32 s4, s4, 10
s_add_u32 s4, s4, s5
v_lshl_add_u32 v9, v0, 4, s4
s_mul_i32 s4, s3, 6
s_add_u32 s4, s4, 2
s_lshr_b32 s5, s4, 2
s_mul_i32 s5, s5, 294912
s_and_b32 s4, s4, 3
s_lshl_b32 s4, s4, 10
s_add_u32 s4, s4, s5
v_lshl_add_u32 v10, v0, 4, s4
s_mul_i32 s4, s3, 6
s_add_u32 s4, s4, 3
s_lshr_b32 s5, s4, 2
s_mul_i32 s5, s5, 294912
s_and_b32 s4, s4, 3
s_lshl_b32 s4, s4, 10
s_add_u32 s4, s4, s5
v_lshl_add_u32 v11, v0, 4, s4
s_mul_i32 s4, s3, 6
s_add_u32 s4, s4, 4
s_lshr_b32 s5, s4, 2
s_mul_i32 s5, s5, 294912
s_and_b32 s4, s4, 3
s_lshl_b32 s4, s4, 10
s_add_u32 s4, s4, s5
v_lshl_add_u32 v12, v0, 4, s4
s_mul_i32 s4, s3, 6
s_add_u32 s4, s4, 5
s_lshr_b32 s5, s4, 2
s_mul_i32 s5, s5, 294912
s_and_b32 s4, s4, 3
s_lshl_b32 s4, s4, 10
s_add_u32 s4, s4, s5
v_lshl_add_u32 v13, v0, 4, s4
s_mul_i32 s53, s3, 6144
s_add_u32 s53, s53, 0
s_mul_i32 s4, s3, 4
s_add_u32 s4, s4, 0
s_lshl_b32 s4, s4, 6
v_add_u32 v1, s4, v0
v_mul_u32_u24 v2, 4096, v1
v_lshrrev_b32 v2, 16, v2
v_mul_u32_u24 v3, 16, v2
v_sub_u32 v3, v1, v3
v_and_b32 v4, 3, v2
v_lshlrev_b32 v4, 2, v4
v_xor_b32 v3, v3, v4
v_mul_u32_u24 v2, 4096, v2
v_lshl_add_u32 v14, v3, 4, v2
s_mul_i32 s4, s3, 4
s_add_u32 s4, s4, 1
s_lshl_b32 s4, s4, 6
v_add_u32 v1, s4, v0
v_mul_u32_u24 v2, 4096, v1
v_lshrrev_b32 v2, 16, v2
v_mul_u32_u24 v3, 16, v2
v_sub_u32 v3, v1, v3
v_and_b32 v4, 3, v2
v_lshlrev_b32 v4, 2, v4
v_xor_b32 v3, v3, v4
v_mul_u32_u24 v2, 4096, v2
v_lshl_add_u32 v15, v3, 4, v2
s_mul_i32 s4, s3, 4
s_add_u32 s4, s4, 2
s_lshl_b32 s4, s4, 6
v_add_u32 v1, s4, v0
v_mul_u32_u24 v2, 4096, v1
v_lshrrev_b32 v2, 16, v2
v_mul_u32_u24 v3, 16, v2
v_sub_u32 v3, v1, v3
v_and_b32 v4, 3, v2
v_lshlrev_b32 v4, 2, v4
v_xor_b32 v3, v3, v4
v_mul_u32_u24 v2, 4096, v2
v_lshl_add_u32 v16, v3, 4, v2
s_mul_i32 s4, s3, 4
s_add_u32 s4, s4, 3
s_lshl_b32 s4, s4, 6
v_add_u32 v1, s4, v0
v_mul_u32_u24 v2, 4096, v1
v_lshrrev_b32 v2, 16, v2
v_mul_u32_u24 v3, 16, v2
v_sub_u32 v3, v1, v3
v_and_b32 v4, 3, v2
v_lshlrev_b32 v4, 2, v4
v_xor_b32 v3, v3, v4
v_mul_u32_u24 v2, 4096, v2
v_lshl_add_u32 v17, v3, 4, v2
s_mul_i32 s54, s3, 4096
s_add_u32 s54, s54, 24576
s_waitcnt lgkmcnt(0)
s_add_u32 s8, s8, 32505856
s_addc_u32 s9, s9, 0
s_mov_b32 s10, 5308416
s_mov_b32 s11, 0x20000
s_mov_b32 s14, 18874368
s_mov_b32 s15, 0x20000
s_add_u32 s16, s16, 4194304
s_addc_u32 s17, s17, 0
s_mov_b32 s18, 11796480
s_mov_b32 s19, 0x20000
s_mov_b32 s40, s64
s_mov_b32 s44, s64
s_mov_b32 s41, 0
s_mov_b32 s43, 0
s_mov_b32 s45, 40960
s_cmp_gt_i32 s44, 0
s_cselect_b32 s10, s10, 0
s_cselect_b32 s14, s14, 0
s_sub_u32 s44, s44, 1
s_add_u32 m0, s41, s53
s_nop 0
buffer_load_dwordx4 v8, s[8:11], s50 offen lds
s_add_u32 m0, m0, 1024
s_nop 0
buffer_load_dwordx4 v9, s[8:11], s50 offen lds
s_add_u32 m0, m0, 1024
s_nop 0
buffer_load_dwordx4 v10, s[8:11], s50 offen lds
s_add_u32 m0, m0, 1024
s_nop 0
buffer_load_dwordx4 v11, s[8:11], s50 offen lds
s_add_u32 m0, m0, 1024
s_nop 0
buffer_load_dwordx4 v12, s[8:11], s50 offen lds
s_add_u32 m0, m0, 1024
s_nop 0
buffer_load_dwordx4 v13, s[8:11], s50 offen lds
s_add_u32 s50, s50, 4096
s_add_u32 m0, s41, s54
s_nop 0
buffer_load_dwordx4 v14, s[12:15], s51 offen lds
s_add_u32 m0, m0, 1024
s_nop 0
buffer_load_dwordx4 v15, s[12:15], s51 offen lds
s_add_u32 m0, m0, 1024
s_nop 0
buffer_load_dwordx4 v16, s[12:15], s51 offen lds
s_add_u32 m0, m0, 1024
s_nop 0
buffer_load_dwordx4 v17, s[12:15], s51 offen lds
s_add_u32 s51, s51, 262144
s_add_u32 s41, s41, 40960
s_cmp_eq_u32 s41, 163840
s_cselect_b32 s41, 0, s41
s_cmp_gt_i32 s44, 0
s_cselect_b32 s10, s10, 0
s_cselect_b32 s14, s14, 0
s_sub_u32 s44, s44, 1
s_add_u32 m0, s41, s53
s_nop 0
buffer_load_dwordx4 v8, s[8:11], s50 offen lds
s_add_u32 m0, m0, 1024
s_nop 0
buffer_load_dwordx4 v9, s[8:11], s50 offen lds
s_add_u32 m0, m0, 1024
s_nop 0
buffer_load_dwordx4 v10, s[8:11], s50 offen lds
s_add_u32 m0, m0, 1024
s_nop 0
buffer_load_dwordx4 v11, s[8:11], s50 offen lds
s_add_u32 m0, m0, 1024
s_nop 0
buffer_load_dwordx4 v12, s[8:11], s50 offen lds
s_add_u32 m0, m0, 1024
s_nop 0
buffer_load_dwordx4 v13, s[8:11], s50 offen lds
s_add_u32 s50, s50, 4096
s_add_u32 m0, s41, s54
s_nop 0
buffer_load_dwordx4 v14, s[12:15], s51 offen lds
s_add_u32 m0, m0, 1024
s_nop 0
buffer_load_dwordx4 v15, s[12:15], s51 offen lds
s_add_u32 m0, m0, 1024
s_nop 0
buffer_load_dwordx4 v16, s[12:15], s51 offen lds
s_add_u32 m0, m0, 1024
s_nop 0
buffer_load_dwordx4 v17, s[12:15], s51 offen lds
s_add_u32 s51, s51, 262144
s_add_u32 s41, s41, 40960
s_cmp_eq_u32 s41, 163840
s_cselect_b32 s41, 0, s41
s_cmp_gt_i32 s44, 0
s_cselect_b32 s10, s10, 0
s_cselect_b32 s14, s14, 0
s_sub_u32 s44, s44, 1
s_add_u32 m0, s41, s53
s_nop 0
buffer_load_dwordx4 v8, s[8:11], s50 offen lds
s_add_u32 m0, m0, 1024
s_nop 0
buffer_load_dwordx4 v9, s[8:11], s50 offen lds
s_add_u32 m0, m0, 1024
s_nop 0
buffer_load_dwordx4 v10, s[8:11], s50 offen lds
s_add_u32 m0, m0, 1024
s_nop 0
buffer_load_dwordx4 v11, s[8:11], s50 offen lds
s_add_u32 m0, m0, 1024
s_nop 0
buffer_load_dwordx4 v12, s[8:11], s50 offen lds
s_add_u32 m0, m0, 1024
s_nop 0
buffer_load_dwordx4 v13, s[8:11], s50 offen lds
s_add_u32 s50, s50, 4096
s_add_u32 m0, s41, s54
s_nop 0
buffer_load_dwordx4 v14, s[12:15], s51 offen lds
s_add_u32 m0, m0, 1024
s_nop 0
buffer_load_dwordx4 v15, s[12:15], s51 offen lds
s_add_u32 m0, m0, 1024
s_nop 0
buffer_load_dwordx4 v16, s[12:15], s51 offen lds
s_add_u32 m0, m0, 1024
s_nop 0
buffer_load_dwordx4 v17, s[12:15], s51 offen lds
s_add_u32 s51, s51, 262144
s_add_u32 s41, s41, 40960
s_cmp_eq_u32 s41, 163840
s_cselect_b32 s41, 0, s41
s_cmp_gt_i32 s44, 0
s_cselect_b32 s10, s10, 0
s_cselect_b32 s14, s14, 0
s_sub_u32 s44, s44, 1
s_add_u32 m0, s41, s53
s_nop 0
buffer_load_dwordx4 v8, s[8:11], s50 offen lds
s_add_u32 m0, m0, 1024
s_nop 0
buffer_load_dwordx4 v9, s[8:11], s50 offen lds
s_add_u32 m0, m0, 1024
s_nop 0
buffer_load_dwordx4 v10, s[8:11], s50 offen lds
s_add_u32 m0, m0, 1024
s_nop 0
buffer_load_dwordx4 v11, s[8:11], s50 offen lds
s_add_u32 m0, m0, 1024
s_nop 0
buffer_load_dwordx4 v12, s[8:11], s50 offen lds
s_add_u32 m0, m0, 1024
s_nop 0
buffer_load_dwordx4 v13, s[8:11], s50 offen lds
s_add_u32 s50, s50, 4096
s_add_u32 m0, s41, s54
s_nop 0
buffer_load_dwordx4 v14, s[12:15], s51 offen lds
s_add_u32 m0, m0, 1024
s_nop 0
buffer_load_dwordx4 v15, s[12:15], s51 offen lds
s_add_u32 m0, m0, 1024
s_nop 0
buffer_load_dwordx4 v16, s[12:15], s51 offen lds
s_add_u32 m0, m0, 1024
s_nop 0
buffer_load_dwordx4 v17, s[12:15], s51 offen lds
s_add_u32 s51, s51, 262144
s_add_u32 s41, s41, 40960
s_cmp_eq_u32 s41, 163840
s_cselect_b32 s41, 0, s41
s_waitcnt vmcnt(30)
s_barrier
.mlp2_L2:
s_waitcnt vmcnt(20)
s_barrier
s_cmp_gt_i32 s44, 0
s_cselect_b32 s10, s10, 0
s_cselect_b32 s14, s14, 0
s_sub_u32 s44, s44, 1
s_add_u32 m0, s41, s53
s_nop 0
buffer_load_dwordx4 v8, s[8:11], s50 offen lds
s_add_u32 m0, m0, 1024
s_nop 0
buffer_load_dwordx4 v9, s[8:11], s50 offen lds
s_add_u32 m0, m0, 1024
s_nop 0
buffer_load_dwordx4 v10, s[8:11], s50 offen lds
s_add_u32 m0, m0, 1024
s_nop 0
buffer_load_dwordx4 v11, s[8:11], s50 offen lds
s_add_u32 m0, m0, 1024
s_nop 0
buffer_load_dwordx4 v12, s[8:11], s50 offen lds
s_add_u32 m0, m0, 1024
s_nop 0
buffer_load_dwordx4 v13, s[8:11], s50 offen lds
s_add_u32 s50, s50, 4096
s_add_u32 m0, s41, s54
s_nop 0
buffer_load_dwordx4 v14, s[12:15], s51 offen lds
s_add_u32 m0, m0, 1024
s_nop 0
buffer_load_dwordx4 v15, s[12:15], s51 offen lds
s_add_u32 m0, m0, 1024
s_nop 0
buffer_load_dwordx4 v16, s[12:15], s51 offen lds
s_add_u32 m0, m0, 1024
s_nop 0
buffer_load_dwordx4 v17, s[12:15], s51 offen lds
s_add_u32 s51, s51, 262144
s_add_u32 s41, s41, 40960
s_cmp_eq_u32 s41, 163840
s_cselect_b32 s41, 0, s41
s_sub_u32 s40, s40, 1
s_cmp_lg_u32 s40, 0
s_cbranch_scc1 .mlp2_L2
s_waitcnt vmcnt(0) lgkmcnt(0)
s_nop 7
s_nop 7
s_endpgm
.mlp2_L1:
s_lshl_b32 s4, s56, 12
s_add_u32 s4, s4, 0
v_lshl_add_u32 v8, v0, 4, s4
v_bfe_u32 v1, v0, 2, 2
v_lshrrev_b32 v2, 5, v0
v_lshl_add_u32 v2, v2, 2, v1
v_mul_u32_u24 v2, 256, v2
v_bfe_u32 v3, v0, 4, 1
v_lshl_add_u32 v2, v3, 5, v2
v_and_b32 v3, 3, v0
v_lshl_add_u32 v2, v3, 3, v2
v_add_u32 v2, 24576, v2
s_add_u32 s4, s57, 0
v_xor_b32 v3, s4, v1
v_lshl_add_u32 v9, v3, 6, v2
s_add_u32 s4, s57, 1
v_xor_b32 v3, s4, v1
v_lshl_add_u32 v10, v3, 6, v2
s_waitcnt lgkmcnt(0)
s_add_u32 s8, s8, 32505856
s_addc_u32 s9, s9, 0
s_mov_b32 s10, 5308416
s_mov_b32 s11, 0x20000
s_mov_b32 s14, 18874368
s_mov_b32 s15, 0x20000
s_add_u32 s16, s16, 4194304
s_addc_u32 s17, s17, 0
s_mov_b32 s18, 11796480
s_mov_b32 s19, 0x20000
s_mov_b32 s40, s64
s_mov_b32 s44, s64
s_mov_b32 s41, 0
s_mov_b32 s43, 0
s_mov_b32 s45, 40960
v_mov_b32 v64, 0
v_mov_b32 v65, 0
v_mov_b32 v66, 0
v_mov_b32 v67, 0
v_mov_b32 v68, 0
v_mov_b32 v69, 0
v_mov_b32 v70, 0
v_mov_b32 v71, 0
v_mov_b32 v72, 0
v_mov_b32 v73, 0
v_mov_b32 v74, 0
v_mov_b32 v75, 0
v_mov_b32 v76, 0
v_mov_b32 v77, 0
v_mov_b32 v78, 0
v_mov_b32 v79, 0
v_mov_b32 v80, 0
v_mov_b32 v81, 0
v_mov_b32 v82, 0
v_mov_b32 v83, 0
v_mov_b32 v84, 0
v_mov_b32 v85, 0
v_mov_b32 v86, 0
v_mov_b32 v87, 0
v_mov_b32 v88, 0
v_mov_b32 v89, 0
v_mov_b32 v90, 0
v_mov_b32 v91, 0
v_mov_b32 v92, 0
v_mov_b32 v93, 0
v_mov_b32 v94, 0
v_mov_b32 v95, 0
v_mov_b32 v96, 0
v_mov_b32 v97, 0
v_mov_b32 v98, 0
v_mov_b32 v99, 0
v_mov_b32 v100, 0
v_mov_b32 v101, 0
v_mov_b32 v102, 0
v_mov_b32 v103, 0
v_mov_b32 v104, 0
v_mov_b32 v105, 0
v_mov_b32 v106, 0
v_mov_b32 v107, 0
v_mov_b32 v108, 0
v_mov_b32 v109, 0
v_mov_b32 v110, 0
v_mov_b32 v111, 0
v_mov_b32 v112, 0
v_mov_b32 v113, 0
v_mov_b32 v114, 0
v_mov_b32 v115, 0
v_mov_b32 v116, 0
v_mov_b32 v117, 0
v_mov_b32 v118, 0
v_mov_b32 v119, 0
v_mov_b32 v120, 0
v_mov_b32 v121, 0
v_mov_b32 v122, 0
v_mov_b32 v123, 0
v_mov_b32 v124, 0
v_mov_b32 v125, 0
v_mov_b32 v126, 0
v_mov_b32 v127, 0
v_mov_b32 v128, 0
v_mov_b32 v129, 0
v_mov_b32 v130, 0
v_mov_b32 v131, 0
v_mov_b32 v132, 0
v_mov_b32 v133, 0
v_mov_b32 v134, 0
v_mov_b32 v135, 0
v_mov_b32 v136, 0
v_mov_b32 v137, 0
v_mov_b32 v138, 0
v_mov_b32 v139, 0
v_mov_b32 v140, 0
v_mov_b32 v141, 0
v_mov_b32 v142, 0
v_mov_b32 v143, 0
v_mov_b32 v144, 0
v_mov_b32 v145, 0
v_mov_b32 v146, 0
v_mov_b32 v147, 0
v_mov_b32 v148, 0
v_mov_b32 v149, 0
v_mov_b32 v150, 0
v_mov_b32 v151, 0
v_mov_b32 v152, 0
v_mov_b32 v153, 0
v_mov_b32 v154, 0
v_mov_b32 v155, 0
v_mov_b32 v156, 0
v_mov_b32 v157, 0
v_mov_b32 v158, 0
v_mov_b32 v159, 0
s_barrier
ds_read_b128 v[24:27], v8 offset:0
ds_read_b128 v[28:31], v8 offset:4096
ds_read_b128 v[32:35], v8 offset:8192
ds_read_b64_tr_b16 v[36:37], v9 offset:0
ds_read_b64_tr_b16 v[38:39], v9 offset:2048
ds_read_b64_tr_b16 v[40:41], v10 offset:0
ds_read_b64_tr_b16 v[42:43], v10 offset:2048
.mlp2_L3:
ds_read_b128 v[44:47], v8 offset:1024
ds_read_b128 v[48:51], v8 offset:5120
ds_read_b128 v[52:55], v8 offset:9216
s_waitcnt lgkmcnt(3)
v_mfma_f32_32x32x16_bf16 v[64:79], v[24:27], v[36:39], v[64:79]
ds_read_b64_tr_b16 v[56:57], v9 offset:4096
ds_read_b64_tr_b16 v[58:59], v9 offset:6144
v_mfma_f32_32x32x16_bf16 v[80:95], v[24:27], v[40:43], v[80:95]
ds_read_b64_tr_b16 v[60:61], v10 offset:4096
ds_read_b64_tr_b16 v[62:63], v10 offset:6144
v_mfma_f32_32x32x16_bf16 v[96:111], v[28:31], v[36:39], v[96:111]
v_mfma_f32_32x32x16_bf16 v[112:127], v[28:31], v[40:43], v[112:127]
v_mfma_f32_32x32x16_bf16 v[128:143], v[32:35], v[36:39], v[128:143]
v_mfma_f32_32x32x16_bf16 v[144:159], v[32:35], v[40:43], v[144:159]
ds_read_b128 v[24:27], v8 offset:2048
ds_read_b128 v[28:31], v8 offset:6144
ds_read_b128 v[32:35], v8 offset:10240
s_waitcnt lgkmcnt(3)
v_mfma_f32_32x32x16_bf16 v[64:79], v[44:47], v[56:59], v[64:79]
ds_read_b64_tr_b16 v[36:37], v9 offset:8192
ds_read_b64_tr_b16 v[38:39], v9 offset:10240
v_mfma_f32_32x32x16_bf16 v[80:95], v[44:47], v[60:63], v[80:95]
ds_read_b64_tr_b16 v[40:41], v10 offset:8192
ds_read_b64_tr_b16 v[42:43], v10 offset:10240
v_mfma_f32_32x32x16_bf16 v[96:111], v[48:51], v[56:59], v[96:111]
v_mfma_f32_32x32x16_bf16 v[112:127], v[48:51], v[60:63], v[112:127]
v_mfma_f32_32x32x16_bf16 v[128:143], v[52:55], v[56:59], v[128:143]
v_mfma_f32_32x32x16_bf16 v[144:159], v[52:55], v[60:63], v[144:159]
ds_read_b128 v[44:47], v8 offset:3072
ds_read_b128 v[48:51], v8 offset:7168
ds_read_b128 v[52:55], v8 offset:11264
s_waitcnt lgkmcnt(3)
v_mfma_f32_32x32x16_bf16 v[64:79], v[24:27], v[36:39], v[64:79]
ds_read_b64_tr_b16 v[56:57], v9 offset:12288
ds_read_b64_tr_b16 v[58:59], v9 offset:14336
v_mfma_f32_32x32x16_bf16 v[80:95], v[24:27], v[40:43], v[80:95]
ds_read_b64_tr_b16 v[60:61], v10 offset:12288
ds_read_b64_tr_b16 v[62:63], v10 offset:14336
v_mfma_f32_32x32x16_bf16 v[96:111], v[28:31], v[36:39], v[96:111]
v_mfma_f32_32x32x16_bf16 v[112:127], v[28:31], v[40:43], v[112:127]
v_mfma_f32_32x32x16_bf16 v[128:143], v[32:35], v[36:39], v[128:143]
v_mfma_f32_32x32x16_bf16 v[144:159], v[32:35], v[40:43], v[144:159]
s_add_u32 s43, s43, 40960
s_cmp_eq_u32 s43, 163840
s_cselect_b32 s42, -122880, s45
s_cselect_b32 s43, 0, s43
s_waitcnt lgkmcnt(0)
v_add_u32 v8, s42, v8
v_add_u32 v9, s42, v9
v_add_u32 v10, s42, v10
s_barrier
ds_read_b128 v[24:27], v8 offset:0
ds_read_b128 v[28:31], v8 offset:4096
ds_read_b128 v[32:35], v8 offset:8192
v_mfma_f32_32x32x16_bf16 v[64:79], v[44:47], v[56:59], v[64:79]
ds_read_b64_tr_b16 v[36:37], v9 offset:0
ds_read_b64_tr_b16 v[38:39], v9 offset:2048
v_mfma_f32_32x32x16_bf16 v[80:95], v[44:47], v[60:63], v[80:95]
ds_read_b64_tr_b16 v[40:41], v10 offset:0
ds_read_b64_tr_b16 v[42:43], v10 offset:2048
v_mfma_f32_32x32x16_bf16 v[96:111], v[48:51], v[56:59], v[96:111]
v_mfma_f32_32x32x16_bf16 v[112:127], v[48:51], v[60:63], v[112:127]
v_mfma_f32_32x32x16_bf16 v[128:143], v[52:55], v[56:59], v[128:143]
v_mfma_f32_32x32x16_bf16 v[144:159], v[52:55], v[60:63], v[144:159]
s_sub_u32 s40, s40, 1
s_cmp_lg_u32 s40, 0
s_cbranch_scc1 .mlp2_L3
s_waitcnt vmcnt(0) lgkmcnt(0)
s_nop 7
s_nop 7
s_lshl_b32 s4, s60, 6
s_lshl_b32 s5, s62, 2
s_add_u32 s4, s4, s5
s_add_u32 s4, s4, s57
s_mul_i32 s4, s4, 18
s_mul_i32 s5, s61, 6
s_add_u32 s4, s4, s5
s_add_u32 s4, s4, s56
s_lshl_b32 s4, s4, 11
v_lshlrev_b32 v1, 4, v0
s_add_u32 s5, s4, 0
v_cvt_pk_bf16_f32 v16, v64, v65
v_cvt_pk_bf16_f32 v17, v66, v67
v_cvt_pk_bf16_f32 v18, v68, v69
v_cvt_pk_bf16_f32 v19, v70, v71
buffer_store_dwordx4 v[16:19], v1, s[16:19], s5 offen offset:0 sc1
v_cvt_pk_bf16_f32 v20, v72, v73
v_cvt_pk_bf16_f32 v21, v74, v75
v_cvt_pk_bf16_f32 v22, v76, v77
v_cvt_pk_bf16_f32 v23, v78, v79
buffer_store_dwordx4 v[20:23], v1, s[16:19], s5 offen offset:1024 sc1
s_add_u32 s5, s4, 36864
v_cvt_pk_bf16_f32 v24, v80, v81
v_cvt_pk_bf16_f32 v25, v82, v83
v_cvt_pk_bf16_f32 v26, v84, v85
v_cvt_pk_bf16_f32 v27, v86, v87
buffer_store_dwordx4 v[24:27], v1, s[16:19], s5 offen offset:0 sc1
v_cvt_pk_bf16_f32 v28, v88, v89
v_cvt_pk_bf16_f32 v29, v90, v91
v_cvt_pk_bf16_f32 v30, v92, v93
v_cvt_pk_bf16_f32 v31, v94, v95
buffer_store_dwordx4 v[28:31], v1, s[16:19], s5 offen offset:1024 sc1
s_add_u32 s5, s4, 2048
v_cvt_pk_bf16_f32 v32, v96, v97
v_cvt_pk_bf16_f32 v33, v98, v99
v_cvt_pk_bf16_f32 v34, v100, v101
v_cvt_pk_bf16_f32 v35, v102, v103
buffer_store_dwordx4 v[32:35], v1, s[16:19], s5 offen offset:0 sc1
v_cvt_pk_bf16_f32 v36, v104, v105
v_cvt_pk_bf16_f32 v37, v106, v107
v_cvt_pk_bf16_f32 v38, v108, v109
v_cvt_pk_bf16_f32 v39, v110, v111
buffer_store_dwordx4 v[36:39], v1, s[16:19], s5 offen offset:1024 sc1
s_add_u32 s5, s4, 38912
v_cvt_pk_bf16_f32 v40, v112, v113
v_cvt_pk_bf16_f32 v41, v114, v115
v_cvt_pk_bf16_f32 v42, v116, v117
v_cvt_pk_bf16_f32 v43, v118, v119
buffer_store_dwordx4 v[40:43], v1, s[16:19], s5 offen offset:0 sc1
v_cvt_pk_bf16_f32 v44, v120, v121
v_cvt_pk_bf16_f32 v45, v122, v123
v_cvt_pk_bf16_f32 v46, v124, v125
v_cvt_pk_bf16_f32 v47, v126, v127
buffer_store_dwordx4 v[44:47], v1, s[16:19], s5 offen offset:1024 sc1
s_add_u32 s5, s4, 4096
v_cvt_pk_bf16_f32 v48, v128, v129
v_cvt_pk_bf16_f32 v49, v130, v131
v_cvt_pk_bf16_f32 v50, v132, v133
v_cvt_pk_bf16_f32 v51, v134, v135
buffer_store_dwordx4 v[48:51], v1, s[16:19], s5 offen offset:0 sc1
v_cvt_pk_bf16_f32 v52, v136, v137
v_cvt_pk_bf16_f32 v53, v138, v139
v_cvt_pk_bf16_f32 v54, v140, v141
v_cvt_pk_bf16_f32 v55, v142, v143
buffer_store_dwordx4 v[52:55], v1, s[16:19], s5 offen offset:1024 sc1
s_add_u32 s5, s4, 40960
v_cvt_pk_bf16_f32 v56, v144, v145
v_cvt_pk_bf16_f32 v57, v146, v147
v_cvt_pk_bf16_f32 v58, v148, v149
v_cvt_pk_bf16_f32 v59, v150, v151
buffer_store_dwordx4 v[56:59], v1, s[16:19], s5 offen offset:0 sc1
v_cvt_pk_bf16_f32 v60, v152, v153
v_cvt_pk_bf16_f32 v61, v154, v155
v_cvt_pk_bf16_f32 v62, v156, v157
v_cvt_pk_bf16_f32 v63, v158, v159
buffer_store_dwordx4 v[60:63], v1, s[16:19], s5 offen offset:1024 sc1
.mlp2_end:
s_endpgm
.globl fin_kernel
.p2align 8
.type fin_kernel,@function
fin_kernel:
s_cmp_ge_u32 s2, 256
s_cbranch_scc1 .fin_end
s_and_b32 s4, s2, 7
s_lshr_b32 s5, s2, 5
s_lshl_b32 s5, s5, 3
s_add_u32 s4, s4, s5
s_bfe_u32 s5, s2, 0x20003
s_lshl_b32 s4, s4, 2
s_add_u32 s2, s4, s5
s_load_dwordx2 s[8:9], s[0:1], 104
s_load_dwordx2 s[12:13], s[0:1], 104
s_load_dwordx2 s[16:17], s[0:1], 88
s_load_dwordx2 s[20:21], s[0:1], 80
v_and_b32 v1, 7, v0
v_lshrrev_b32 v2, 3, v0
s_lshr_b32 s4, s2, 2
s_mul_i32 s4, s4, 36864
s_and_b32 s5, s2, 3
s_lshl_b32 s5, s5, 7
s_add_u32 s4, s4, s5
v_lshlrev_b32 v3, 9, v2
v_lshl_add_u32 v3, v1, 4, v3
v_lshrrev_b32 v4, 1, v2
v_mul_u32_u24 v5, 1152, v1
v_lshl_add_u32 v5, v4, 5, v5
v_and_b32 v4, 1, v2
v_lshl_add_u32 v5, v4, 3, v5
s_mul_i32 s6, s2, 9216
s_waitcnt lgkmcnt(0)
s_add_u32 s8, s8, 4194304
s_addc_u32 s9, s9, 0
s_mov_b32 s10, 11796480
s_mov_b32 s11, 0x20000
s_add_u32 s12, s12, 27787264
s_addc_u32 s13, s13, 0
s_mov_b32 s14, 2359296
s_mov_b32 s15, 0x20000
s_mov_b32 s18, 2359296
s_mov_b32 s19, 0x20000
s_mov_b32 s22, 4096
s_mov_b32 s23, 0x20000
buffer_load_dwordx4 v[40:43], v3, s[8:11], s4 offen
s_add_u32 s4, s4, 2359296
buffer_load_dwordx4 v[44:47], v3, s[8:11], s4 offen
s_add_u32 s4, s4, 2359296
buffer_load_dwordx4 v[48:51], v3, s[8:11], s4 offen
s_add_u32 s4, s4, 2359296
buffer_load_dwordx4 v[52:55], v3, s[8:11], s4 offen
s_add_u32 s4, s4, 2359296
buffer_load_dwordx4 v[56:59], v3, s[8:11], s4 offen
s_add_u32 s4, s4, 2359296
buffer_load_dwordx2 v[8:9], v5, s[12:15], s6 offen
buffer_load_dwordx2 v[10:11], v5, s[12:15], s6 offen offset:16
s_lshl_b32 s7, s2, 4
v_lshlrev_b32 v6, 1, v1
buffer_load_ushort v12, v6, s[20:23], s7 offen
s_waitcnt vmcnt(7)
v_lshlrev_b32 v16, 16, v40
v_and_b32 v17, 0xffff0000, v40
v_lshlrev_b32 v18, 16, v41
v_and_b32 v19, 0xffff0000, v41
v_lshlrev_b32 v20, 16, v42
v_and_b32 v21, 0xffff0000, v42
v_lshlrev_b32 v22, 16, v43
v_and_b32 v23, 0xffff0000, v43
s_waitcnt vmcnt(6)
v_lshlrev_b32 v24, 16, v44
v_and_b32 v25, 0xffff0000, v44
v_lshlrev_b32 v26, 16, v45
v_and_b32 v27, 0xffff0000, v45
v_lshlrev_b32 v28, 16, v46
v_and_b32 v29, 0xffff0000, v46
v_lshlrev_b32 v30, 16, v47
v_and_b32 v31, 0xffff0000, v47
v_add_f32 v16, v16, v24
v_add_f32 v17, v17, v25
v_add_f32 v18, v18, v26
v_add_f32 v19, v19, v27
v_add_f32 v20, v20, v28
v_add_f32 v21, v21, v29
v_add_f32 v22, v22, v30
v_add_f32 v23, v23, v31
s_waitcnt vmcnt(5)
v_lshlrev_b32 v24, 16, v48
v_and_b32 v25, 0xffff0000, v48
v_lshlrev_b32 v26, 16, v49
v_and_b32 v27, 0xffff0000, v49
v_lshlrev_b32 v28, 16, v50
v_and_b32 v29, 0xffff0000, v50
v_lshlrev_b32 v30, 16, v51
v_and_b32 v31, 0xffff0000, v51
v_add_f32 v16, v16, v24
v_add_f32 v17, v17, v25
v_add_f32 v18, v18, v26
v_add_f32 v19, v19, v27
v_add_f32 v20, v20, v28
v_add_f32 v21, v21, v29
v_add_f32 v22, v22, v30
v_add_f32 v23, v23, v31
s_waitcnt vmcnt(4)
v_lshlrev_b32 v24, 16, v52
v_and_b32 v25, 0xffff0000, v52
v_lshlrev_b32 v26, 16, v53
v_and_b32 v27, 0xffff0000, v53
v_lshlrev_b32 v28, 16, v54
v_and_b32 v29, 0xffff0000, v54
v_lshlrev_b32 v30, 16, v55
v_and_b32 v31, 0xffff0000, v55
v_add_f32 v16, v16, v24
v_add_f32 v17, v17, v25
v_add_f32 v18, v18, v26
v_add_f32 v19, v19, v27
v_add_f32 v20, v20, v28
v_add_f32 v21, v21, v29
v_add_f32 v22, v22, v30
v_add_f32 v23, v23, v31
s_waitcnt vmcnt(3)
v_lshlrev_b32 v24, 16, v56
v_and_b32 v25, 0xffff0000, v56
v_lshlrev_b32 v26, 16, v57
v_and_b32 v27, 0xffff0000, v57
v_lshlrev_b32 v28, 16, v58
v_and_b32 v29, 0xffff0000, v58
v_lshlrev_b32 v30, 16, v59
v_and_b32 v31, 0xffff0000, v59
v_add_f32 v16, v16, v24
v_add_f32 v17, v17, v25
v_add_f32 v18, v18, v26
v_add_f32 v19, v19, v27
v_add_f32 v20, v20, v28
v_add_f32 v21, v21, v29
v_add_f32 v22, v22, v30
v_add_f32 v23, v23, v31
s_waitcnt vmcnt(0)
v_lshlrev_b32 v12, 16, v12
v_add_f32 v16, v16, v12
v_add_f32 v17, v17, v12
v_add_f32 v18, v18, v12
v_add_f32 v19, v19, v12
v_add_f32 v20, v20, v12
v_add_f32 v21, v21, v12
v_add_f32 v22, v22, v12
v_add_f32 v23, v23, v12
v_cvt_pk_bf16_f32 v24, v16, v17
v_cvt_pk_bf16_f32 v25, v18, v19
v_cvt_pk_bf16_f32 v26, v20, v21
v_cvt_pk_bf16_f32 v27, v22, v23
v_lshlrev_b32 v16, 16, v24
v_and_b32 v17, 0xffff0000, v24
v_lshlrev_b32 v18, 16, v25
v_and_b32 v19, 0xffff0000, v25
v_lshlrev_b32 v20, 16, v26
v_and_b32 v21, 0xffff0000, v26
v_lshlrev_b32 v22, 16, v27
v_and_b32 v23, 0xffff0000, v27
v_lshlrev_b32 v32, 16, v8
v_and_b32 v33, 0xffff0000, v8
v_lshlrev_b32 v34, 16, v9
v_and_b32 v35, 0xffff0000, v9
v_lshlrev_b32 v36, 16, v10
v_and_b32 v37, 0xffff0000, v10
v_lshlrev_b32 v38, 16, v11
v_and_b32 v39, 0xffff0000, v11
v_add_f32 v16, v16, v32
v_add_f32 v17, v17, v33
v_add_f32 v18, v18, v34
v_add_f32 v19, v19, v35
v_add_f32 v20, v20, v36
v_add_f32 v21, v21, v37
v_add_f32 v22, v22, v38
v_add_f32 v23, v23, v39
v_cvt_pk_bf16_f32 v24, v16, v17
v_cvt_pk_bf16_f32 v25, v18, v19
v_cvt_pk_bf16_f32 v26, v20, v21
v_cvt_pk_bf16_f32 v27, v22, v23
v_lshlrev_b32 v16, 16, v24
v_and_b32 v17, 0xffff0000, v24
v_lshlrev_b32 v18, 16, v25
v_and_b32 v19, 0xffff0000, v25
v_lshlrev_b32 v20, 16, v26
v_and_b32 v21, 0xffff0000, v26
v_lshlrev_b32 v22, 16, v27
v_and_b32 v23, 0xffff0000, v27
buffer_store_dwordx2 v[24:25], v5, s[16:19], s6 offen
buffer_store_dwordx2 v[26:27], v5, s[16:19], s6 offen offset:16
.fin_end:
s_endpgm
.section .rodata,"a"
.p2align 6
.amdhsa_kernel kv_kernel
  .amdhsa_next_free_vgpr 224
  .amdhsa_next_free_sgpr 102
  .amdhsa_accum_offset 224
  .amdhsa_group_segment_fixed_size 0
  .amdhsa_kernarg_size 112
  .amdhsa_user_sgpr_count 2
  .amdhsa_user_sgpr_kernarg_segment_ptr 1
  .amdhsa_system_sgpr_workgroup_id_x 1
.end_amdhsa_kernel
.p2align 6
.amdhsa_kernel attn_kernel
  .amdhsa_next_free_vgpr 244
  .amdhsa_next_free_sgpr 102
  .amdhsa_accum_offset 244
  .amdhsa_group_segment_fixed_size 0
  .amdhsa_kernarg_size 112
  .amdhsa_user_sgpr_count 2
  .amdhsa_user_sgpr_kernarg_segment_ptr 1
  .amdhsa_system_sgpr_workgroup_id_x 1
.end_amdhsa_kernel
.p2align 6
.amdhsa_kernel oproj_kernel
  .amdhsa_next_free_vgpr 160
  .amdhsa_next_free_sgpr 102
  .amdhsa_accum_offset 160
  .amdhsa_group_segment_fixed_size 0
  .amdhsa_kernarg_size 112
  .amdhsa_user_sgpr_count 2
  .amdhsa_user_sgpr_kernarg_segment_ptr 1
  .amdhsa_system_sgpr_workgroup_id_x 1
.end_amdhsa_kernel
.p2align 6
.amdhsa_kernel ln2_kernel
  .amdhsa_next_free_vgpr 64
  .amdhsa_next_free_sgpr 102
  .amdhsa_accum_offset 64
  .amdhsa_group_segment_fixed_size 0
  .amdhsa_kernarg_size 112
  .amdhsa_user_sgpr_count 2
  .amdhsa_user_sgpr_kernarg_segment_ptr 1
  .amdhsa_system_sgpr_workgroup_id_x 1
.end_amdhsa_kernel
.p2align 6
.amdhsa_kernel mlp1_kernel
  .amdhsa_next_free_vgpr 176
  .amdhsa_next_free_sgpr 102
  .amdhsa_accum_offset 176
  .amdhsa_group_segment_fixed_size 0
  .amdhsa_kernarg_size 112
  .amdhsa_user_sgpr_count 2
  .amdhsa_user_sgpr_kernarg_segment_ptr 1
  .amdhsa_system_sgpr_workgroup_id_x 1
.end_amdhsa_kernel
.p2align 6
.amdhsa_kernel mlp2_kernel
  .amdhsa_next_free_vgpr 160
  .amdhsa_next_free_sgpr 102
  .amdhsa_accum_offset 160
  .amdhsa_group_segment_fixed_size 0
  .amdhsa_kernarg_size 112
  .amdhsa_user_sgpr_count 2
  .amdhsa_user_sgpr_kernarg_segment_ptr 1
  .amdhsa_system_sgpr_workgroup_id_x 1
.end_amdhsa_kernel
.p2align 6
.amdhsa_kernel fin_kernel
  .amdhsa_next_free_vgpr 64
  .amdhsa_next_free_sgpr 102
  .amdhsa_accum_offset 64
  .amdhsa_group_segment_fixed_size 0
  .amdhsa_kernarg_size 112
  .amdhsa_user_sgpr_count 2
  .amdhsa_user_sgpr_kernarg_segment_ptr 1
  .amdhsa_system_sgpr_workgroup_id_x 1
.end_amdhsa_kernel
```
